```python
import torch

def _softmax(x, axis=-1):
    return torch.softmax(x, dim=axis)

def _gelu(x):
    return torch.nn.functional.gelu(x, approximate='tanh')

def _silu(x):
    return torch.nn.functional.silu(x)

def _sigmoid(x):
    return torch.sigmoid(x)

def _layernorm(x, axis=-1, eps=1e-05):
    m = x.mean(dim=axis, keepdim=True)
    v = x.var(dim=axis, keepdim=True, unbiased=False)
    return (x - m) / torch.sqrt(v + eps)

def _scatter_add(tgt, idx, src, axis=0):
    return tgt.clone().index_add_(axis, idx, src)

def _segment_sum(src, seg, n):
    out = torch.zeros((n,) + src.shape[1:], dtype=src.dtype)
    return out.index_add_(0, seg, src)

def _pad(x, pw):
    flat = tuple((v for pair in reversed(pw) for v in pair))
    return torch.nn.functional.pad(x, flat)
kernel_name = 'adaLN_cond__spectral_gfnet__glu_gated_bilinear__prompt'

def setup_inputs():

    _w = lambda a: (lambda t: t.to(torch.bfloat16) if t.is_floating_point() else t)(torch.as_tensor(a))

    def _A_setup():
        B, S, D = (1, 2048, 640)
        Df = D // 2 + 1
        return {'x': _w((lambda *s: torch.randn(*s, dtype=torch.bfloat16) * 0.05)(B, S, D)), 'w_r': _w((lambda *s: torch.randn(*s, dtype=torch.bfloat16) * 1.6)(S, Df) * 0.02), 'w_i': _w((lambda *s: torch.randn(*s, dtype=torch.bfloat16) * 1.6)(S, Df) * 0.02)}
    _A_in = _A_setup()

    def _B_setup():
        B, S, D, F = (1, 2048, 640, 1536)
        return {'x': _w((lambda *s: torch.randn(*s, dtype=torch.bfloat16) * 0.05)(B, S, D)), 'w_gate': _w((lambda *s: torch.randn(*s, dtype=torch.bfloat16) * 0.4)(D, F) * D ** (-0.5)), 'w_up': _w((lambda *s: torch.randn(*s, dtype=torch.bfloat16) * 0.4)(D, F) * D ** (-0.5)), 'w_down': _w((lambda *s: torch.randn(*s, dtype=torch.bfloat16) * 0.4)(F, D) * F ** (-0.5))}
    _B_in = _B_setup()
    return {'A_x': _A_in['x'], 'A_w_r': _A_in['w_r'], 'A_w_i': _A_in['w_i'], 'B_x': _B_in['x'], 'B_w_gate': _B_in['w_gate'], 'B_w_up': _B_in['w_up'], 'B_w_down': _B_in['w_down'], 'c': _w((lambda *s: torch.randn(*s, dtype=torch.bfloat16) * 0.1)(1, 640) * 8.0), 'w_mod': _w((lambda *s: torch.randn(*s, dtype=torch.bfloat16) * 0.1)(640, 6 * 640) * 640 ** (-0.5) * 8.0)}

def reference(A_x, A_w_r, A_w_i, B_x, B_w_gate, B_w_up, B_w_down, c, w_mod):

    def _A_ref(x, w_r, w_i):
        B, S, D = x.shape
        X = (lambda x, axes=(-2, -1): torch.fft.rfft2(x.float(), dim=axes))(x, axes=(-2, -1))
        W = w_r + 1j * w_i
        X = X * W
        y = (lambda x, s, axes=(-2, -1): torch.fft.irfft2(x, s=s, dim=axes).to(torch.bfloat16))(X, (S, D), axes=(-2, -1))
        return y

    def _B_ref(x, w_gate, w_up, w_down):
        g = torch.einsum('bsd,df->bsf', x, w_gate)
        u = torch.einsum('bsd,df->bsf', x, w_up)
        h = g * u
        return torch.einsum('bsf,fd->bsd', h, w_down)
    x = A_x
    mod = (_silu(c) @ w_mod).reshape(c.shape[0], 6, 1, -1)
    sa, ca, ga, sb, cb, gb = (mod[:, 0].clone(), mod[:, 1].clone(), mod[:, 2].clone(), mod[:, 3].clone(), mod[:, 4].clone(), mod[:, 5].clone())
    h = _layernorm(x, axis=-1) * (1 + ca) + sa
    x = x + ga * _A_ref(h, A_w_r, A_w_i)
    h = _layernorm(x, axis=-1) * (1 + cb) + sb
    x = x + gb * _B_ref(h, B_w_gate, B_w_up, B_w_down)
    return x
```

```asm
; @launch grid=(256,1,1) block=(512,1,1) lds=163840
.amdgcn_target "amdgcn-amd-amdhsa--gfx950"
.text
.globl adaLN_cond__spectral_gfnet__glu_gated_bilinear__prompt_kernel
.p2align 8
.type adaLN_cond__spectral_gfnet__glu_gated_bilinear__prompt_kernel,@function
adaLN_cond__spectral_gfnet__glu_gated_bilinear__prompt_kernel:
    s_cmp_ge_u32 s2, 256
    s_cbranch_scc1 L_end
    s_getpc_b64 s[4:5]
L_pc:
    v_lshlrev_b32 v20, 7, v0
    v_min_u32 v20, L_codeend-L_pc, v20
    global_load_dword v86, v20, s[4:5]
    s_load_dwordx2 s[28:29], s[0:1], 64
    s_load_dwordx2 s[24:25], s[0:1], 56
    s_load_dwordx2 s[36:37], s[0:1], 88
    s_load_dwordx2 s[8:9], s[0:1], 0
    s_load_dwordx2 s[12:13], s[0:1], 8
    s_load_dwordx2 s[16:17], s[0:1], 16
    s_load_dwordx2 s[32:33], s[0:1], 72
    s_load_dwordx4 s[76:79], s[0:1], 32
    s_load_dwordx2 s[80:81], s[0:1], 48
    v_lshrrev_b32 v22, 6, v0
    v_lshrrev_b32 v24, 3, v0
    v_readfirstlane_b32 s41, v22
    v_and_b32 v0, 63, v0
    v_lshlrev_b32 v1, 4, v0
    s_and_b32 s47, s2, 7
    s_lshr_b32 s48, s2, 3
    s_mov_b32 s60, s2
    v_lshlrev_b32 v25, 1, v24
    v_and_b32 v26, 0x70, v1
    v_mul_u32_u24 v24, 7680, v24
    v_add_u32 v24, v24, v26
    s_and_b32 s94, s60, 3
    s_mul_i32 s93, s94, 320
    s_mul_i32 s90, s94, 1228800
    s_lshr_b32 s94, s60, 2
    s_lshl_b32 s94, s94, 7
    s_add_u32 s90, s90, s94
    s_cmp_lt_u32 s2, 240
    s_cselect_b32 s90, s90, 4915200
    s_add_u32 s91, s90, 491520
    s_add_u32 s92, s90, 983040
    s_cmp_lt_u32 s41, 4
    s_cselect_b32 s92, s92, 4915200
    s_mov_b32 s30, 4915200
    s_mov_b32 s31, 0x20000
    s_mov_b32 s26, 1280
    s_mov_b32 s27, 0x20000
    s_waitcnt lgkmcnt(0)
    s_load_dword s40, s[36:37], 0
    buffer_load_ushort v184, v25, s[24:27], s93 offen offset:0
    buffer_load_ushort v185, v25, s[24:27], s93 offen offset:128
    buffer_load_ushort v186, v25, s[24:27], s93 offen offset:256
    buffer_load_dwordx4 v[32:35], v24, s[28:31], s90 offen
    buffer_load_dwordx4 v[36:39], v24, s[28:31], s91 offen
    buffer_load_dwordx4 v[40:43], v24, s[28:31], s92 offen
    s_mov_b32 s38, 19922944
    s_mov_b32 s39, 0x20000
    s_mov_b32 s10, 2621440
    s_mov_b32 s11, 0x20000
    s_mov_b32 s14, 1314816
    s_mov_b32 s15, 0x20000
    s_mov_b32 s18, 1314816
    s_mov_b32 s19, 0x20000
    s_mov_b32 s34, 2621440
    s_mov_b32 s35, 0x20000
    s_mov_b32 s22, 1966080
    s_mov_b32 s23, 0x20000
    v_lshrrev_b32 v2, 4, v0
    v_and_b32 v3, 15, v0
    s_and_b32 s3, s47, 3
    s_lshl_b32 s3, s3, 2
    s_lshr_b32 s50, s48, 3
    s_add_u32 s50, s50, s3
    s_and_b32 s53, s48, 7
    s_lshr_b32 s3, s47, 2
    s_lshl_b32 s3, s3, 3
    s_add_u32 s51, s53, s3
    s_lshl_b32 s42, s50, 4
    s_add_u32 s42, s42, s51
    s_mov_b32 s43, 0
    v_mul_u32_u24 v4, 320, v2
    v_lshl_add_u32 v4, v3, 2, v4
    s_lshl_b32 s89, s41, 8
    s_add_u32 s89, s89, s42
    s_mul_i32 s89, s89, 1280
    s_lshl_b32 s88, s48, 3
    s_add_u32 s88, s88, s41
    s_lshl_b32 s88, s88, 3
    s_add_u32 s88, s88, s47
    s_mul_i32 s88, s88, 642
    v_lshlrev_b32 v27, 7, v0
    v_min_u32 v27, 640, v27
    s_sub_u32 s84, s2, 160
    s_and_b32 s85, s84, 1
    s_lshr_b32 s84, s84, 1
    s_mul_i32 s86, s85, 640
    s_lshr_b32 s3, s41, 2
    s_mul_i32 s3, s3, 384
    s_add_u32 s86, s86, s3
    s_mul_i32 s3, s47, 384
    s_movk_i32 s87, 3072
    s_cmp_lt_u32 s2, 160
    s_cselect_b32 s84, s48, s84
    s_cselect_b32 s86, s3, s86
    s_cselect_b32 s87, s87, 1280
    s_lshl_b32 s3, s84, 2
    s_and_b32 s6, s41, 3
    s_add_u32 s3, s3, s6
    s_lshl_b32 s3, s3, 3
    s_mul_i32 s3, s3, s87
    s_add_u32 s86, s86, s3
    v_lshrrev_b32 v28, 3, v0
    v_mul_u32_u24 v28, s87, v28
    v_add_u32 v28, v28, v26
    s_cmp_lt_u32 s41, 4
    s_cselect_b64 s[20:21], s[76:77], s[78:79]
    s_cmp_lt_u32 s2, 160
    s_cselect_b64 s[20:21], s[20:21], s[80:81]
    s_barrier
    s_lshl_b32 s83, s41, 11
    s_add_u32 s83, s83, 106496
    s_mov_b32 m0, s83
    s_nop 0
    buffer_load_dwordx4 v1, s[8:11], s89 offen lds
    s_mov_b64 exec, 0xffff
    buffer_load_dwordx4 v1, s[8:11], s89 offen offset:1024 lds
    s_mov_b64 exec, -1
    v_add_u32 v195, s83, v4
    s_lshl_b32 s3, s41, 11
    s_add_u32 s6, s4, tab_data-L_pc+0
    s_addc_u32 s7, s5, 0
    s_add_u32 s6, s6, s3
    s_addc_u32 s7, s7, 0
    s_add_u32 m0, s3, 8192
    s_nop 0
    global_load_lds_dwordx4 v1, s[6:7] offset:0
    global_load_lds_dwordx4 v1, s[6:7] offset:1024
    s_cmp_ge_u32 s2, 240
    s_cselect_b32 s60, s2, s60
    s_cmp_ge_u32 s60, 80
    s_cbranch_scc0 L_sk_1
    s_mov_b64 exec, 0x3f
    buffer_load_ushort v86, v27, s[12:15], s88 offen
    buffer_load_ushort v86, v27, s[16:19], s88 offen
    s_mov_b64 exec, -1
    s_mul_i32 s3, s41, 3072
    s_add_u32 m0, s3, 73728
    s_nop 0
    buffer_load_dwordx4 v28, s[20:23], s86 offen offset:0 lds
    s_add_u32 m0, s3, 74624
    s_nop 0
    buffer_load_dwordx4 v28, s[20:23], s86 offen offset:128 lds
    s_add_u32 m0, s3, 75520
    s_nop 0
    buffer_load_dwordx4 v28, s[20:23], s86 offen offset:256 lds
L_sk_1:
    v_lshrrev_b32 v85, 3, v3
    v_lshrrev_b32 v44, 5, v0
    v_lshl_add_u32 v20, v44, 1, v85
    v_mul_u32_u24 v20, 30720, v20
    v_sub_u32 v85, v3, v85
    v_and_b32 v21, 7, v0
    v_and_b32 v45, 1, v2
    v_lshl_add_u32 v21, v45, 3, v21
    v_lshl_add_u32 v20, v21, 4, v20
    s_mul_i32 s70, s41, 1280
    s_add_u32 s70, s70, 262144
    s_mul_i32 s3, s41, 320
    v_lshl_add_u32 v21, v21, 2, s3
    v_lshl_add_u32 v21, v44, 1, v21
    s_sub_u32 s72, s2, 240
    s_lshl_b32 s72, s72, 3
    s_add_u32 s72, s72, s41
    s_lshl_b32 s74, s72, 8
    s_add_u32 s74, s74, 272384
    v_lshrrev_b32 v44, 1, v3
    v_lshl_add_u32 v45, v2, 1, 0
    v_lshl_add_u32 v45, v45, 8, s42
    v_mul_u32_u24 v44, v44, v45
    v_and_b32 v45, 1, v3
    v_mul_u32_u24 v45, 512, v45
    v_add_u32 v44, v44, v45
    v_and_b32 v44, 2047, v44
    v_cvt_f32_u32 v44, v44
    v_mul_f32 v44, 0x3a000000, v44
    v_cos_f32 v46, v44
    v_sin_f32 v47, v44
    s_nop 0
    v_cvt_pk_bf16_f32 v18, v46, v47
    v_lshrrev_b32 v44, 1, v3
    v_lshl_add_u32 v45, v2, 1, 1
    v_lshl_add_u32 v45, v45, 8, s42
    v_mul_u32_u24 v44, v44, v45
    v_and_b32 v45, 1, v3
    v_mul_u32_u24 v45, 512, v45
    v_add_u32 v44, v44, v45
    v_and_b32 v44, 2047, v44
    v_cvt_f32_u32 v44, v44
    v_mul_f32 v44, 0x3a000000, v44
    v_cos_f32 v46, v44
    v_sin_f32 v47, v44
    s_nop 0
    v_cvt_pk_bf16_f32 v19, v46, v47
    v_lshlrev_b32 v87, 1, v4
    s_lshr_b32 s68, s41, 1
    s_mul_i32 s68, s68, 2688
    s_and_b32 s69, s41, 1
    s_lshl_b32 s69, s69, 2
    s_add_u32 s68, s68, s69
    s_add_u32 s68, s68, 40960
    v_add_u32 v15, s68, v87
    s_add_u32 s69, s68, 2080
    v_sub_u32 v16, s69, v87
    v_mul_u32_u24 v17, 2688, v2
    v_lshl_add_u32 v17, v85, 3, v17
    s_mul_i32 s68, s41, 112
    s_add_u32 s68, s68, 40960
    v_add_u32 v17, s68, v17
    s_cmp_lt_u32 s41, 4
    s_cselect_b32 s71, 0, 1.0
    s_mov_b32 s3, 98304
    v_lshl_add_u32 v196, v21, 1, s3
    v_add_u32 v197, s3, v87
    s_sub_u32 s3, s72, 40
    s_cmp_lt_u32 s3, 20
    s_cselect_b32 s73, 1.0, 0
    s_lshl_b32 s75, s72, 7
    s_add_u32 s75, s75, 4096
    s_mov_b32 s64, 0x80808080
    s_mov_b32 s65, 0x80808080
    s_not_b64 s[66:67], s[64:65]
    s_mul_i32 s44, s42, 1664
    s_add_u32 s44, s44, 1048576
    s_mov_b32 s3, 851968
    v_mul_lo_u32 v6, v2, s3
    v_lshl_add_u32 v6, v3, 2, v6
    s_lshl_b32 s3, s41, 6
    v_add_u32 v6, s3, v6
    v_add_u32 v7, 425984, v6
    v_and_b32 v44, 3, v0
    v_lshlrev_b32 v44, 3, v44
    s_cmp_ge_u32 s2, 160
    s_cbranch_scc1 L_rpB_2
    s_mul_i32 s3, s41, 48
    v_add_u32 v216, s3, v44
    v_add_u32 v217, 384, v216
    v_lshrrev_b32 v45, 4, v44
    v_mul_u32_u24 v45, 368, v45
    v_add3_u32 v218, v216, v45, 32
    s_lshl_b32 s68, s47, 3
    s_add_u32 s68, s68, s41
    s_mul_i32 s68, s68, 20
    s_add_u32 s68, s68, s84
    s_mul_i32 s68, s68, 3072
    s_add_u32 s56, s68, 13631488
    s_add_u32 s57, s68, 13632512
    s_add_u32 s58, s68, 13633536
    s_branch L_rpJ_3
L_rpB_2:
    s_mul_i32 s3, s41, 96
    v_add_u32 v216, s3, v44
    v_add_u32 v217, 32, v216
    v_add_u32 v218, 64, v216
    s_mul_i32 s82, s85, 192
    s_add_u32 s82, s82, s84
    s_mul_i32 s82, s82, 5
    s_mul_i32 s68, s41, 3
    s_add_u32 s68, s68, 0
    s_mul_i32 s69, s68, 52
    s_lshr_b32 s69, s69, 8
    s_mul_i32 s69, s69, 235
    s_add_u32 s69, s69, s68
    s_add_u32 s69, s69, s82
    s_lshl_b32 s69, s69, 10
    s_add_u32 s69, s69, 17825792
    s_cmp_lt_u32 s68, 20
    s_cselect_b32 s56, s69, 19922944
    s_mul_i32 s68, s41, 3
    s_add_u32 s68, s68, 1
    s_mul_i32 s69, s68, 52
    s_lshr_b32 s69, s69, 8
    s_mul_i32 s69, s69, 235
    s_add_u32 s69, s69, s68
    s_add_u32 s69, s69, s82
    s_lshl_b32 s69, s69, 10
    s_add_u32 s69, s69, 17825792
    s_cmp_lt_u32 s68, 20
    s_cselect_b32 s57, s69, 19922944
    s_mul_i32 s68, s41, 3
    s_add_u32 s68, s68, 2
    s_mul_i32 s69, s68, 52
    s_lshr_b32 s69, s69, 8
    s_mul_i32 s69, s69, 235
    s_add_u32 s69, s69, s68
    s_add_u32 s69, s69, s82
    s_lshl_b32 s69, s69, 10
    s_add_u32 s69, s69, 17825792
    s_cmp_lt_u32 s68, 20
    s_cselect_b32 s58, s69, 19922944
L_rpJ_3:
    v_bfe_u32 v44, v0, 2, 2
    v_lshlrev_b32 v44, 7, v44
    v_mul_u32_u24 v45, 3072, v2
    s_mov_b32 s3, 73728
    v_add3_u32 v44, v44, v45, s3
    v_lshrrev_b32 v45, 7, v216
    v_mul_u32_u24 v46, 11, v45
    v_lshrrev_b32 v46, 5, v46
    v_mul_u32_u24 v46, 9216, v46
    v_mul_u32_u24 v45, 896, v45
    v_add3_u32 v216, v216, v45, v46
    v_add_u32 v216, v216, v44
    v_lshrrev_b32 v45, 7, v217
    v_mul_u32_u24 v46, 11, v45
    v_lshrrev_b32 v46, 5, v46
    v_mul_u32_u24 v46, 9216, v46
    v_mul_u32_u24 v45, 896, v45
    v_add3_u32 v217, v217, v45, v46
    v_add_u32 v217, v217, v44
    v_lshrrev_b32 v45, 7, v218
    v_mul_u32_u24 v46, 11, v45
    v_lshrrev_b32 v46, 5, v46
    v_mul_u32_u24 v46, 9216, v46
    v_mul_u32_u24 v45, 896, v45
    v_add3_u32 v218, v218, v45, v46
    v_add_u32 v218, v218, v44
    s_cmp_ge_u32 s2, 240
    s_cbranch_scc1 L_nu_4
    v_lshlrev_b32 v191, 1, v26
    v_lshl_add_u32 v191, v2, 3, v191
    s_lshl_b32 s3, s41, 8
    s_add_u32 s3, s3, 104448
    v_add_u32 v191, s3, v191
    s_and_b32 s68, s60, 3
    s_mul_i32 s68, s68, 30720
    s_lshr_b32 s69, s60, 2
    s_lshl_b32 s69, s69, 9
    s_add_u32 s68, s68, s69
    s_add_u32 s68, s68, 262144
    v_lshlrev_b32 v192, 2, v0
    v_add_u32 v192, 104448, v192
    v_lshlrev_b32 v193, 3, v0
    s_waitcnt vmcnt(12)
    s_cmp_lt_u32 s60, 80
    s_cbranch_scc0 L_sk_5
    s_waitcnt vmcnt(7)
L_sk_5:
    v_lshlrev_b32 v184, 16, v184
    v_mul_f32 v188, 0xbfb8aa3b, v184
    v_lshlrev_b32 v185, 16, v185
    v_mul_f32 v189, 0xbfb8aa3b, v185
    v_lshlrev_b32 v186, 16, v186
    v_mul_f32 v190, 0xbfb8aa3b, v186
    v_exp_f32 v188, v188
    v_exp_f32 v189, v189
    v_exp_f32 v190, v190
    v_add_f32 v188, 1.0, v188
    v_add_f32 v189, 1.0, v189
    v_add_f32 v190, 1.0, v190
    v_rcp_f32 v188, v188
    v_rcp_f32 v189, v189
    v_rcp_f32 v190, v190
    v_mul_f32 v188, v188, v184
    v_mul_f32 v189, v189, v185
    v_mul_f32 v190, v190, v186
    v_cvt_pk_bf16_f32 v184, v188, 0
    v_cvt_pk_bf16_f32 v185, v189, 0
    v_cvt_pk_bf16_f32 v186, v190, 0
    v_lshlrev_b32 v188, 16, v184
    v_lshlrev_b32 v189, 16, v185
    v_lshlrev_b32 v190, 16, v186
    s_waitcnt vmcnt(9)
    s_cmp_lt_u32 s60, 80
    s_cbranch_scc0 L_sk_6
    s_waitcnt vmcnt(4)
L_sk_6:
    v_dot2_f32_bf16 v176, v32, v184, 0
    v_dot2_f32_bf16 v177, v32, v188, 0
    v_dot2_f32_bf16 v178, v33, v184, 0
    v_dot2_f32_bf16 v179, v33, v188, 0
    v_dot2_f32_bf16 v180, v34, v184, 0
    v_dot2_f32_bf16 v181, v34, v188, 0
    v_dot2_f32_bf16 v182, v35, v184, 0
    v_dot2_f32_bf16 v183, v35, v188, 0
    v_dot2_f32_bf16 v176, v36, v185, v176
    v_dot2_f32_bf16 v177, v36, v189, v177
    v_dot2_f32_bf16 v178, v37, v185, v178
    v_dot2_f32_bf16 v179, v37, v189, v179
    v_dot2_f32_bf16 v180, v38, v185, v180
    v_dot2_f32_bf16 v181, v38, v189, v181
    v_dot2_f32_bf16 v182, v39, v185, v182
    v_dot2_f32_bf16 v183, v39, v189, v183
    v_dot2_f32_bf16 v176, v40, v186, v176
    v_dot2_f32_bf16 v177, v40, v190, v177
    v_dot2_f32_bf16 v178, v41, v186, v178
    v_dot2_f32_bf16 v179, v41, v190, v179
    v_dot2_f32_bf16 v180, v42, v186, v180
    v_dot2_f32_bf16 v181, v42, v190, v181
    v_dot2_f32_bf16 v182, v43, v186, v182
    v_dot2_f32_bf16 v183, v43, v190, v183
    v_permlane32_swap_b32 v176, v180
    v_permlane32_swap_b32 v177, v181
    v_permlane32_swap_b32 v178, v182
    v_permlane32_swap_b32 v179, v183
    v_add_f32 v176, v176, v180
    v_add_f32 v177, v177, v181
    v_add_f32 v178, v178, v182
    v_add_f32 v179, v179, v183
    s_nop 0
    v_permlane16_swap_b32 v176, v178
    v_permlane16_swap_b32 v177, v179
    v_add_f32 v176, v176, v178
    v_add_f32 v177, v177, v179
    s_nop 0
    v_add_f32_dpp v176, v176, v176 row_ror:8 row_mask:0xf bank_mask:0xf
    v_add_f32_dpp v177, v177, v177 row_ror:8 row_mask:0xf bank_mask:0xf
    ds_write_b64 v191, v[176:177]
    s_waitcnt lgkmcnt(0)
    s_barrier
    s_cmp_lg_u32 s41, 0
    s_cbranch_scc1 L_nu_4
    ds_read2st64_b32 v[204:205], v192 offset0:0 offset1:1
    ds_read2st64_b32 v[206:207], v192 offset0:2 offset1:3
    ds_read2st64_b32 v[208:209], v192 offset0:4 offset1:5
    ds_read2st64_b32 v[210:211], v192 offset0:6 offset1:7
    s_add_u32 s3, s40, 1
    s_waitcnt lgkmcnt(0)
    v_pk_add_f32 v[204:205], v[204:205], v[206:207]
    v_pk_add_f32 v[208:209], v[208:209], v[210:211]
    v_pk_add_f32 v[204:205], v[204:205], v[208:209]
    v_add_f32 v204, v204, v205
    v_mov_b32 v205, s3
    buffer_store_dwordx2 v[204:205], v193, s[36:39], s68 offen sc1
L_nu_4:
    s_cmp_lt_u32 s60, 80
    s_cbranch_scc0 L_sk_7
    s_mov_b64 exec, 0x3f
    buffer_load_ushort v86, v27, s[12:15], s88 offen
    buffer_load_ushort v86, v27, s[16:19], s88 offen
    s_mov_b64 exec, -1
    s_mul_i32 s3, s41, 3072
    s_add_u32 m0, s3, 73728
    s_nop 0
    buffer_load_dwordx4 v28, s[20:23], s86 offen offset:0 lds
    s_add_u32 m0, s3, 74624
    s_nop 0
    buffer_load_dwordx4 v28, s[20:23], s86 offen offset:128 lds
    s_add_u32 m0, s3, 75520
    s_nop 0
    buffer_load_dwordx4 v28, s[20:23], s86 offen offset:256 lds
L_sk_7:
    s_waitcnt vmcnt(7) lgkmcnt(0)
    ds_read_b32 v10, v195 offset:0
    ds_read_b32 v11, v195 offset:64
    ds_read_b32 v12, v195 offset:128
    ds_read_b32 v13, v195 offset:192
    ds_read_b32 v14, v195 offset:256
    s_waitcnt lgkmcnt(0)
    s_add_u32 s40, s40, 1
    v_lshlrev_b32 v100, 16, v10
    v_and_b32 v101, 0xffff0000, v10
    v_lshlrev_b32 v102, 16, v11
    v_and_b32 v103, 0xffff0000, v11
    v_lshlrev_b32 v104, 16, v12
    v_and_b32 v105, 0xffff0000, v12
    v_lshlrev_b32 v106, 16, v13
    v_and_b32 v107, 0xffff0000, v13
    v_lshlrev_b32 v108, 16, v14
    v_and_b32 v109, 0xffff0000, v14
    v_readfirstlane_b32 s61, v100
    s_nop 1
    v_subrev_f32 v100, s61, v100
    v_subrev_f32 v101, s61, v101
    v_subrev_f32 v102, s61, v102
    v_subrev_f32 v103, s61, v103
    v_subrev_f32 v104, s61, v104
    v_subrev_f32 v105, s61, v105
    v_subrev_f32 v106, s61, v106
    v_subrev_f32 v107, s61, v107
    v_subrev_f32 v108, s61, v108
    v_subrev_f32 v109, s61, v109
    v_pk_add_f32 v[44:45], v[100:101], v[102:103]
    v_pk_mul_f32 v[46:47], v[100:101], v[100:101]
    v_pk_fma_f32 v[46:47], v[102:103], v[102:103], v[46:47]
    v_pk_add_f32 v[44:45], v[44:45], v[104:105]
    v_pk_fma_f32 v[46:47], v[104:105], v[104:105], v[46:47]
    v_pk_add_f32 v[44:45], v[44:45], v[106:107]
    v_pk_fma_f32 v[46:47], v[106:107], v[106:107], v[46:47]
    v_pk_add_f32 v[44:45], v[44:45], v[108:109]
    v_pk_fma_f32 v[46:47], v[108:109], v[108:109], v[46:47]
    v_add_f32 v44, v44, v45
    v_add_f32 v46, v46, v47
    v_mov_b32 v45, 0x3acccccd
    v_add_f32_dpp v44, v44, v44 quad_perm:[1,0,3,2] row_mask:0xf bank_mask:0xf
    v_add_f32_dpp v46, v46, v46 quad_perm:[1,0,3,2] row_mask:0xf bank_mask:0xf
    s_nop 0
    v_add_f32_dpp v44, v44, v44 quad_perm:[2,3,0,1] row_mask:0xf bank_mask:0xf
    v_add_f32_dpp v46, v46, v46 quad_perm:[2,3,0,1] row_mask:0xf bank_mask:0xf
    s_nop 0
    v_add_f32_dpp v44, v44, v44 row_ror:4 row_mask:0xf bank_mask:0xf
    v_add_f32_dpp v46, v46, v46 row_ror:4 row_mask:0xf bank_mask:0xf
    s_nop 0
    v_add_f32_dpp v44, v44, v44 row_ror:8 row_mask:0xf bank_mask:0xf
    v_add_f32_dpp v46, v46, v46 row_ror:8 row_mask:0xf bank_mask:0xf
    s_nop 0
    v_add_f32_dpp v44, v44, v44 row_bcast:15 row_mask:0xa bank_mask:0xf
    v_add_f32_dpp v46, v46, v46 row_bcast:15 row_mask:0xa bank_mask:0xf
    s_nop 0
    v_add_f32_dpp v44, v44, v44 row_bcast:31 row_mask:0xc bank_mask:0xf
    v_add_f32_dpp v46, v46, v46 row_bcast:31 row_mask:0xc bank_mask:0xf
    v_readlane_b32 s68, v44, 63
    v_readlane_b32 s69, v46, 63
    s_nop 0
    v_mul_f32 v44, s68, v45
    v_mul_f32 v46, s69, v45
    v_fma_f32 v46, -v44, v44, v46
    v_max_f32 v46, 0, v46
    v_add_f32 v46, 0x3727c5ac, v46
    v_rsq_f32 v46, v46
    s_nop 0
    v_mul_f32 v47, v44, v46
    v_pk_fma_f32 v[100:101], v[100:101], v[46:47], v[46:47] op_sel:[0,0,1] op_sel_hi:[1,0,1] neg_lo:[0,0,1] neg_hi:[0,0,1]
    v_pk_fma_f32 v[102:103], v[102:103], v[46:47], v[46:47] op_sel:[0,0,1] op_sel_hi:[1,0,1] neg_lo:[0,0,1] neg_hi:[0,0,1]
    v_pk_fma_f32 v[104:105], v[104:105], v[46:47], v[46:47] op_sel:[0,0,1] op_sel_hi:[1,0,1] neg_lo:[0,0,1] neg_hi:[0,0,1]
    v_pk_fma_f32 v[106:107], v[106:107], v[46:47], v[46:47] op_sel:[0,0,1] op_sel_hi:[1,0,1] neg_lo:[0,0,1] neg_hi:[0,0,1]
    v_pk_fma_f32 v[108:109], v[108:109], v[46:47], v[46:47] op_sel:[0,0,1] op_sel_hi:[1,0,1] neg_lo:[0,0,1] neg_hi:[0,0,1]
    v_mov_b32 v157, s40
    v_mov_b32 v159, s40
    s_waitcnt vmcnt(5)
    s_barrier
    buffer_load_dwordx4 v[136:139], v20, s[36:39], s70 offen offset:0 sc1
    buffer_load_dwordx4 v[140:143], v20, s[36:39], s70 offen offset:256 sc1
    buffer_load_dwordx4 v[144:147], v20, s[36:39], s70 offen offset:512 sc1
    buffer_load_dwordx4 v[148:151], v20, s[36:39], s70 offen offset:768 sc1
    buffer_load_dwordx4 v[152:155], v20, s[36:39], s70 offen offset:1024 sc1
    s_cmp_lt_u32 s72, 80
    s_cbranch_scc0 L_sk_8
    buffer_load_dwordx4 v[156:159], v20, s[36:39], s74 offen sc1
L_sk_8:
    ds_read_b128 v[48:51], v1 offset:8192
    ds_read_b128 v[52:55], v1 offset:9216
    ds_read_b128 v[56:59], v1 offset:10240
    ds_read_b128 v[60:63], v1 offset:11264
    ds_read_b128 v[64:67], v1 offset:12288
    ds_read_b128 v[68:71], v1 offset:13312
    ds_read_b128 v[112:115], v1 offset:14336
    ds_read_b128 v[116:119], v1 offset:15360
    ds_read_b128 v[120:123], v1 offset:16384
    ds_read_b128 v[124:127], v1 offset:17408
    ds_read_b128 v[128:131], v1 offset:18432
    ds_read_b128 v[132:135], v1 offset:19456
    s_lshl_b32 s3, s41, 11
    s_add_u32 s6, s4, tab_data-L_pc+16384
    s_addc_u32 s7, s5, 0
    s_add_u32 s6, s6, s3
    s_addc_u32 s7, s7, 0
    s_add_u32 m0, s3, 24576
    s_nop 0
    global_load_lds_dwordx4 v1, s[6:7] offset:0
    global_load_lds_dwordx4 v1, s[6:7] offset:1024
    v_mov_b32 v72, s40
    v_mov_b32 v73, s40
    v_mov_b32 v74, s40
    v_mov_b32 v75, s40
    v_mov_b32 v76, s40
    v_mov_b32 v77, s40
    v_mov_b32 v27, 0
    v_mov_b32 v31, 0
    s_waitcnt vmcnt(2)
    v_xor_b32 v45, s40, v137
    v_bitop3_b32 v45, v45, v139, s40 bitop3:0xf6
    v_bitop3_b32 v45, v45, v141, s40 bitop3:0xf6
    v_bitop3_b32 v45, v45, v143, s40 bitop3:0xf6
    v_bitop3_b32 v45, v45, v145, s40 bitop3:0xf6
    v_bitop3_b32 v45, v45, v147, s40 bitop3:0xf6
    v_bitop3_b32 v45, v45, v149, s40 bitop3:0xf6
    v_bitop3_b32 v45, v45, v151, s40 bitop3:0xf6
    v_bitop3_b32 v45, v45, v153, s40 bitop3:0xf6
    v_bitop3_b32 v45, v45, v155, s40 bitop3:0xf6
    v_bitop3_b32 v45, v45, v157, s40 bitop3:0xf6
    v_bitop3_b32 v45, v45, v159, s40 bitop3:0xf6
    v_cmp_ne_u32 vcc, 0, v45
    s_cbranch_vccnz L_rt_9
L_ok_10:
    v_permlane32_swap_b32 v136, v138
    v_permlane32_swap_b32 v140, v142
    v_permlane32_swap_b32 v144, v146
    v_permlane32_swap_b32 v148, v150
    v_permlane32_swap_b32 v152, v154
    v_permlane32_swap_b32 v156, v158
    v_add_f32 v136, v136, v138
    v_add_f32 v140, v140, v142
    v_add_f32 v144, v144, v146
    v_add_f32 v148, v148, v150
    v_add_f32 v152, v152, v154
    v_add_f32 v156, v156, v158
    v_add_f32_dpp v136, v136, v136 row_ror:8 row_mask:0xf bank_mask:0xf
    v_add_f32_dpp v140, v140, v140 row_ror:8 row_mask:0xf bank_mask:0xf
    v_add_f32_dpp v144, v144, v144 row_ror:8 row_mask:0xf bank_mask:0xf
    v_add_f32_dpp v148, v148, v148 row_ror:8 row_mask:0xf bank_mask:0xf
    v_add_f32_dpp v152, v152, v152 row_ror:8 row_mask:0xf bank_mask:0xf
    v_add_f32_dpp v156, v156, v156 row_ror:8 row_mask:0xf bank_mask:0xf
    v_cvt_pk_bf16_f32 v136, 0, v136
    v_cvt_pk_bf16_f32 v140, 0, v140
    v_cvt_pk_bf16_f32 v144, 0, v144
    v_cvt_pk_bf16_f32 v148, 0, v148
    v_cvt_pk_bf16_f32 v152, 0, v152
    v_cvt_pk_bf16_f32 v156, 0, v156
    v_add_f32 v136, s71, v136
    v_add_f32 v140, s71, v140
    v_add_f32 v144, s71, v144
    v_add_f32 v148, s71, v148
    v_add_f32 v152, s71, v152
    v_add_f32 v156, s73, v156
    v_cvt_pk_bf16_f32 v136, 0, v136
    ds_write_b32 v196, v136 offset:0
    v_cvt_pk_bf16_f32 v140, 0, v140
    ds_write_b32 v196, v140 offset:128
    v_cvt_pk_bf16_f32 v144, 0, v144
    ds_write_b32 v196, v144 offset:256
    v_cvt_pk_bf16_f32 v148, 0, v148
    ds_write_b32 v196, v148 offset:384
    v_cvt_pk_bf16_f32 v152, 0, v152
    ds_write_b32 v196, v152 offset:512
    v_cvt_pk_bf16_f32 v156, v156, v156
    ds_write_b16 v21, v156 offset:57344
    v_mul_u32_u24 v198, 164352, v2
    v_lshl_add_u32 v198, v85, 1, v198
    s_mul_i32 s3, s41, 10272
    v_add_u32 v198, s3, v198
    v_add_u32 v199, 5136, v198
    s_mul_i32 s68, s47, 642
    s_mul_i32 s69, s48, 28
    s_add_u32 s68, s68, s69
    s_cmp_lt_u32 s48, 23
    s_cselect_b32 s68, s68, 1314816
    s_add_u32 s3, s68, 0
    buffer_load_ushort v228, v198, s[12:15], s3 offen
    buffer_load_ushort v229, v198, s[16:19], s3 offen
    buffer_load_ushort v236, v199, s[12:15], s3 offen
    buffer_load_ushort v237, v199, s[16:19], s3 offen
    s_add_u32 s3, s68, 82176
    buffer_load_ushort v230, v198, s[12:15], s3 offen
    buffer_load_ushort v231, v198, s[16:19], s3 offen
    buffer_load_ushort v238, v199, s[12:15], s3 offen
    buffer_load_ushort v239, v199, s[16:19], s3 offen
    s_add_u32 s3, s68, 657408
    buffer_load_ushort v232, v198, s[12:15], s3 offen
    buffer_load_ushort v233, v198, s[16:19], s3 offen
    buffer_load_ushort v240, v199, s[12:15], s3 offen
    buffer_load_ushort v241, v199, s[16:19], s3 offen
    s_add_u32 s3, s68, 739584
    buffer_load_ushort v234, v198, s[12:15], s3 offen
    buffer_load_ushort v235, v198, s[16:19], s3 offen
    buffer_load_ushort v242, v199, s[12:15], s3 offen
    buffer_load_ushort v243, v199, s[16:19], s3 offen
    s_waitcnt lgkmcnt(0)
    s_barrier
    ds_read_b64 v[32:33], v197 offset:0
    ds_read_b64 v[88:89], v197 offset:2560
    ds_read_b64 v[34:35], v197 offset:128
    ds_read_b64 v[90:91], v197 offset:2688
    ds_read_b64 v[36:37], v197 offset:256
    ds_read_b64 v[92:93], v197 offset:2816
    ds_read_b64 v[38:39], v197 offset:384
    ds_read_b64 v[94:95], v197 offset:2944
    ds_read_b64 v[40:41], v197 offset:512
    ds_read_b64 v[96:97], v197 offset:3072
    ds_read_b64_tr_b16 v[160:161], v216
    ds_read_b64_tr_b16 v[162:163], v216 offset:512
    ds_read_b64_tr_b16 v[164:165], v217
    ds_read_b64_tr_b16 v[166:167], v217 offset:512
    ds_read_b64_tr_b16 v[168:169], v218
    ds_read_b64_tr_b16 v[170:171], v218 offset:512
    s_waitcnt lgkmcnt(6)
    v_pk_fma_f32 v[100:101], v[100:101], v[88:89], v[32:33]
    v_pk_fma_f32 v[102:103], v[102:103], v[90:91], v[34:35]
    v_pk_fma_f32 v[104:105], v[104:105], v[92:93], v[36:37]
    v_pk_fma_f32 v[106:107], v[106:107], v[94:95], v[38:39]
    v_pk_fma_f32 v[108:109], v[108:109], v[96:97], v[40:41]
    v_cvt_pk_bf16_f32 v24, v100, v102
    v_cvt_pk_bf16_f32 v25, v104, v106
    v_cvt_pk_bf16_f32 v26, v108, 0
    v_cvt_pk_bf16_f32 v28, v101, v103
    v_cvt_pk_bf16_f32 v29, v105, v107
    v_cvt_pk_bf16_f32 v30, v109, 0
    v_mfma_f32_16x16x32_bf16 v[32:35], v[24:27], v[48:51], 0
    v_mfma_f32_16x16x32_bf16 v[40:43], v[24:27], v[52:55], 0
    v_mfma_f32_16x16x32_bf16 v[36:39], v[28:31], v[48:51], 0
    v_mfma_f32_16x16x32_bf16 v[44:47], v[28:31], v[52:55], 0
    s_cmp_lt_u32 s72, 80
    s_cbranch_scc0 L_sk_11
    s_mul_i32 s3, s41, 320
    v_and_b32 v140, 7, v0
    v_lshl_add_u32 v141, v140, 3, s3
    ds_read_b64 v[142:143], v141 offset:57344
    v_lshlrev_b32 v140, 4, v140
    s_waitcnt lgkmcnt(0)
    v_mov_b32 v136, v142
    v_mov_b32 v138, v143
    buffer_store_dwordx4 v[136:139], v140, s[36:39], s75 offen sc1
L_sk_11:
    s_waitcnt lgkmcnt(0)
    buffer_store_dwordx4 v[160:163], v1, s[36:39], s56 offen sc1
    buffer_store_dwordx4 v[164:167], v1, s[36:39], s57 offen sc1
    buffer_store_dwordx4 v[168:171], v1, s[36:39], s58 offen sc1
    v_pk_mul_f32 v[100:101], v[32:33], v[56:57]
    v_pk_mul_f32 v[88:89], v[40:41], v[56:57]
    v_pk_mul_f32 v[102:103], v[34:35], v[58:59]
    v_pk_mul_f32 v[90:91], v[42:43], v[58:59]
    v_pk_mul_f32 v[104:105], v[36:37], v[60:61]
    v_pk_mul_f32 v[92:93], v[44:45], v[60:61]
    v_pk_mul_f32 v[106:107], v[38:39], v[62:63]
    v_pk_mul_f32 v[94:95], v[46:47], v[62:63]
    v_pk_fma_f32 v[100:101], v[40:41], v[64:65], v[100:101]
    v_pk_fma_f32 v[88:89], v[32:33], v[64:65], v[88:89] neg_lo:[1,0,0] neg_hi:[1,0,0]
    v_pk_fma_f32 v[102:103], v[42:43], v[66:67], v[102:103]
    v_pk_fma_f32 v[90:91], v[34:35], v[66:67], v[90:91] neg_lo:[1,0,0] neg_hi:[1,0,0]
    v_pk_fma_f32 v[104:105], v[44:45], v[68:69], v[104:105]
    v_pk_fma_f32 v[92:93], v[36:37], v[68:69], v[92:93] neg_lo:[1,0,0] neg_hi:[1,0,0]
    v_pk_fma_f32 v[106:107], v[46:47], v[70:71], v[106:107]
    v_pk_fma_f32 v[94:95], v[38:39], v[70:71], v[94:95] neg_lo:[1,0,0] neg_hi:[1,0,0]
    v_cvt_pk_bf16_f32 v24, v100, v104
    v_cvt_pk_bf16_f32 v25, v101, v105
    v_cvt_pk_bf16_f32 v26, v102, v106
    v_cvt_pk_bf16_f32 v27, v103, v107
    v_cvt_pk_bf16_f32 v28, v88, v92
    v_cvt_pk_bf16_f32 v29, v89, v93
    v_cvt_pk_bf16_f32 v30, v90, v94
    v_cvt_pk_bf16_f32 v31, v91, v95
    v_mfma_f32_16x16x32_bf16 v[32:35], v[112:115], v[24:27], 0
    v_mfma_f32_16x16x32_bf16 v[36:39], v[120:123], v[24:27], 0
    v_mfma_f32_16x16x32_bf16 v[40:43], v[124:127], v[24:27], 0
    v_mfma_f32_16x16x32_bf16 v[44:47], v[128:131], v[24:27], 0
    v_mfma_f32_16x16x32_bf16 v[32:35], v[116:119], v[28:31], v[32:35]
    v_mfma_f32_16x16x32_bf16 v[36:39], v[112:115], v[28:31], v[36:39]
    v_mfma_f32_16x16x32_bf16 v[40:43], v[128:131], v[28:31], v[40:43]
    v_mfma_f32_16x16x32_bf16 v[44:47], v[132:135], v[28:31], v[44:47]
    v_mov_b32 v200, -1
    v_mov_b32 v201, -1
    v_mov_b32 v202, -1
    v_mov_b32 v203, -1
    v_mov_b32 v84, s40
    v_lshlrev_b32 v23, 28, v2
    v_lshl_add_u32 v23, v3, 2, v23
    v_cvt_pk_bf16_f32 v100, v32, v36
    v_cvt_pk_bf16_f32 v101, v33, v37
    v_cvt_pk_bf16_f32 v102, v34, v38
    v_cvt_pk_bf16_f32 v103, v35, v39
    ds_write2_b32 v15, v100, v101 offset0:0 offset1:40
    ds_write2_b32 v15, v102, v103 offset0:80 offset1:120
    v_cvt_pk_bf16_f32 v104, v40, v44
    v_cvt_pk_bf16_f32 v105, v41, v45
    v_cvt_pk_bf16_f32 v106, v42, v46
    v_cvt_pk_bf16_f32 v107, v43, v47
    ds_write2_b32 v16, v104, v105 offset0:120 offset1:80
    ds_write2_b32 v16, v106, v107 offset0:40 offset1:0
    s_waitcnt lgkmcnt(0)
    s_barrier
    ds_read_b64 v[24:25], v17 offset:0
    ds_read_b64 v[26:27], v17 offset:896
    ds_read_b64 v[28:29], v17 offset:1792
    s_mul_i32 s52, s50, 163840
    s_lshl_b32 s3, s51, 9
    s_add_u32 s52, s52, s3
    s_add_u32 s52, s52, 4718592
    s_lshr_b32 s80, s41, 2
    s_and_b32 s81, s41, 3
    s_lshl_b32 s49, s50, 3
    s_add_u32 s49, s49, s80
    s_mul_i32 s49, s49, 49152
    s_mul_i32 s68, s51, 3072
    s_add_u32 s49, s49, s68
    s_mul_i32 s68, s81, 768
    s_add_u32 s49, s49, s68
    s_add_u32 s49, s49, 7340032
    s_waitcnt lgkmcnt(2)
    v_mfma_f32_16x16x16_bf16 v[32:35], v[18:19], v[24:25], 0
    s_waitcnt lgkmcnt(1)
    v_mfma_f32_16x16x16_bf16 v[36:39], v[18:19], v[26:27], 0
    s_waitcnt lgkmcnt(0)
    v_mfma_f32_16x16x16_bf16 v[40:43], v[18:19], v[28:29], 0
    v_lshrrev_b32 v44, 5, v0
    v_mul_u32_u24 v44, 7680, v44
    v_add_u32 v44, v44, v1
    s_mov_b64 exec, s[66:67]
    v_cvt_pk_bf16_f32 v72, v32, v33
    v_cvt_pk_bf16_f32 v73, v34, v35
    v_cvt_pk_bf16_f32 v74, v36, v37
    v_cvt_pk_bf16_f32 v75, v38, v39
    v_cvt_pk_bf16_f32 v76, v40, v41
    v_cvt_pk_bf16_f32 v77, v42, v43
    s_mov_b64 exec, -1
    buffer_store_dword v72, v6, s[36:39], s44 offen offset:0 sc1
    buffer_store_dword v73, v7, s[36:39], s44 offen offset:0 sc1
    buffer_store_dword v74, v6, s[36:39], s44 offen offset:512 sc1
    buffer_store_dword v75, v7, s[36:39], s44 offen offset:512 sc1
    buffer_store_dword v76, v6, s[36:39], s44 offen offset:1024 sc1
    buffer_store_dword v77, v7, s[36:39], s44 offen offset:1024 sc1
    s_barrier
    s_lshl_b32 s68, s41, 14
    s_add_u32 s68, s68, s52
    buffer_store_dwordx4 v[200:203], v44, s[36:39], s68 offen sc1
    s_add_u32 s68, s68, 131072
    s_cmp_lt_u32 s41, 2
    s_cselect_b32 s68, s68, 19922944
    buffer_store_dwordx4 v[200:203], v44, s[36:39], s68 offen sc1
    s_mov_b32 exec_hi, 0xffff
    s_add_u32 s3, s49, 0
    buffer_store_dwordx4 v[200:203], v1, s[36:39], s3 offen sc1
    s_add_u32 s3, s49, 98304
    buffer_store_dwordx4 v[200:203], v1, s[36:39], s3 offen sc1
    s_mov_b32 exec_hi, -1
    s_xor_b32 s45, s40, 0x80000000
    s_cmp_lt_u32 s41, 7
    s_cselect_b32 s3, 512, 0
    s_add_u32 s59, s44, s3
    s_lshl_b32 s54, s51, 2
    s_add_u32 s54, s54, s81
    s_lshl_b32 s54, s54, 1
    s_add_u32 s54, s54, s80
    s_mul_i32 s54, s54, 30720
    s_add_u32 s54, s54, 13631488
    s_lshl_b32 s55, s53, 3
    s_add_u32 s55, s55, s41
    s_mul_i32 s55, s55, 30720
    s_add_u32 s55, s55, 17825792
    s_lshr_b32 s62, s48, 3
    s_add_u32 s62, s62, s48
    s_and_b32 s62, s62, 1
    s_mul_i32 s63, s62, 0
    s_mul_i32 s62, s62, 1
    s_mul_i32 s3, s62, 3072
    s_add_u32 s54, s54, s3
    s_lshl_b32 s3, s3, 1
    s_sub_u32 s8, 3072, s3
    s_add_u32 s9, s3, 3072
    s_mul_i32 s3, s63, 5120
    s_add_u32 s55, s55, s3
    s_lshl_b32 s3, s3, 1
    s_sub_u32 s10, 1024, s3
    s_add_u32 s11, s3, 1024
    s_mul_i32 s76, s80, 80
    s_lshr_b32 s3, s51, 1
    s_add_u32 s76, s76, s3
    s_mul_i32 s77, s41, 12
    s_lshr_b32 s3, s53, 2
    s_add_u32 s77, s77, s3
    s_add_u32 s77, s77, 140
    v_lshl_add_u32 v17, v3, 3, s76
    v_lshl_add_u32 v44, v3, 1, s77
    v_cmp_gt_u32 vcc, 10, v3
    s_nop 1
    v_cndmask_b32 v17, v44, v17, vcc
    s_lshr_b32 s3, s50, 2
    s_and_b32 s68, s50, 3
    s_lshl_b32 s68, s68, 6
    s_add_u32 s3, s3, s68
    v_and_b32 v44, 7, v0
    v_lshl_add_u32 v44, v44, 3, s3
    v_bfe_u32 v45, v0, 3, 1
    v_lshl_add_u32 v44, v45, 2, v44
    v_cmp_gt_u32 vcc, 16, v0
    s_nop 1
    v_cndmask_b32 v17, v44, v17, vcc
    v_lshlrev_b32 v17, 7, v17
    s_mov_b32 s76, 131072
    v_mov_b32 v87, s40
    s_lshl_b32 s3, s41, 10
    v_add_u32 v20, s3, v1
    v_min_u32 v21, 2032, v20
    s_mov_b32 s70, 4096
    s_mov_b32 s71, 12288
    s_cmp_ge_u32 s48, 23
    s_cbranch_scc1 L_nw_12
    ds_read_b128 v[88:91], v1 offset:20480
    ds_read_b128 v[92:95], v1 offset:21504
    ds_read_b128 v[96:99], v1 offset:22528
    ds_read_b128 v[100:103], v1 offset:23552
    s_lshl_b32 s68, s41, 1
    s_add_u32 s69, s68, 1
    v_lshl_add_u32 v46, v2, 1, 0
    v_mul_u32_u24 v48, s68, v46
    v_cvt_f32_u32 v48, v48
    v_mul_f32 v48, 0x3b800000, v48
    v_sin_f32 v49, v48
    v_cos_f32 v48, v48
    v_mul_u32_u24 v56, s69, v46
    v_cvt_f32_u32 v56, v56
    v_mul_f32 v56, 0x3b800000, v56
    v_sin_f32 v57, v56
    v_cos_f32 v56, v56
    v_lshl_add_u32 v46, v2, 1, 1
    v_mul_u32_u24 v50, s68, v46
    v_cvt_f32_u32 v50, v50
    v_mul_f32 v50, 0x3b800000, v50
    v_sin_f32 v51, v50
    v_cos_f32 v50, v50
    v_mul_u32_u24 v58, s69, v46
    v_cvt_f32_u32 v58, v58
    v_mul_f32 v58, 0x3b800000, v58
    v_sin_f32 v59, v58
    v_cos_f32 v58, v58
    v_lshl_add_u32 v46, v2, 1, 8
    v_mul_u32_u24 v52, s68, v46
    v_cvt_f32_u32 v52, v52
    v_mul_f32 v52, 0x3b800000, v52
    v_sin_f32 v53, v52
    v_cos_f32 v52, v52
    v_mul_u32_u24 v60, s69, v46
    v_cvt_f32_u32 v60, v60
    v_mul_f32 v60, 0x3b800000, v60
    v_sin_f32 v61, v60
    v_cos_f32 v60, v60
    v_lshl_add_u32 v46, v2, 1, 9
    v_mul_u32_u24 v54, s68, v46
    v_cvt_f32_u32 v54, v54
    v_mul_f32 v54, 0x3b800000, v54
    v_sin_f32 v55, v54
    v_cos_f32 v54, v54
    v_mul_u32_u24 v62, s69, v46
    v_cvt_f32_u32 v62, v62
    v_mul_f32 v62, 0x3b800000, v62
    v_sin_f32 v63, v62
    v_cos_f32 v62, v62
    s_lshr_b32 s68, s41, 1
    s_lshl_b32 s68, s68, 8
    s_and_b32 s69, s41, 1
    s_lshl_b32 s69, s69, 3
    s_add_u32 s68, s68, s69
    s_add_u32 s68, s68, 40960
    v_lshlrev_b32 v15, 11, v2
    v_lshl_add_u32 v15, v3, 4, v15
    v_add_u32 v15, s68, v15
    s_lshl_b32 s68, s41, 11
    s_add_u32 s68, s68, 40960
    v_add_u32 v16, s68, v1
    s_mul_i32 s3, s41, 3328
    v_mul_u32_u24 v9, 53248, v2
    v_lshl_add_u32 v8, v3, 2, s3
    v_add_u32 v9, v9, v8
    v_mul_u32_u24 v44, 106496, v2
    v_add_u32 v8, v8, v44
    s_mul_i32 s46, s47, 425984
    s_lshl_b32 s3, s48, 6
    s_add_u32 s46, s46, s3
    s_add_u32 s72, s46, 1048576
    s_add_u32 s73, s46, 1075200
    s_add_u32 s74, s46, 1101824
    s_add_u32 s75, s46, 1128448
    s_add_u32 s78, s46, 1261568
    s_add_u32 s79, s46, 1288192
    v_mov_b32 v128, s45
    v_mov_b32 v129, s45
    v_mov_b32 v130, s45
    v_mov_b32 v131, s45
    v_mov_b32 v132, s45
    v_mov_b32 v133, s45
    v_mov_b32 v134, s45
    v_mov_b32 v135, s45
    s_waitcnt vmcnt(13)
    v_lshlrev_b32 v112, 16, v228
    v_lshlrev_b32 v113, 16, v229
    v_lshlrev_b32 v114, 16, v230
    v_lshlrev_b32 v115, 16, v231
    v_lshlrev_b32 v116, 16, v232
    v_lshlrev_b32 v117, 16, v233
    v_lshlrev_b32 v118, 16, v234
    v_lshlrev_b32 v119, 16, v235
    v_lshlrev_b32 v120, 16, v236
    v_lshlrev_b32 v121, 16, v237
    v_lshlrev_b32 v122, 16, v238
    v_lshlrev_b32 v123, 16, v239
    v_lshlrev_b32 v124, 16, v240
    v_lshlrev_b32 v125, 16, v241
    v_lshlrev_b32 v126, 16, v242
    v_lshlrev_b32 v127, 16, v243
    s_waitcnt vmcnt(0) lgkmcnt(0)
    s_barrier
    buffer_load_dword v24, v8, s[36:39], s72 offen offset:0 sc1
    buffer_load_dword v25, v8, s[36:39], s73 offen offset:0 sc1
    buffer_load_dword v26, v8, s[36:39], s74 offen offset:0 sc1
    buffer_load_dword v27, v8, s[36:39], s75 offen offset:0 sc1
    buffer_load_dword v28, v8, s[36:39], s72 offen offset:1664 sc1
    buffer_load_dword v29, v8, s[36:39], s73 offen offset:1664 sc1
    buffer_load_dword v30, v8, s[36:39], s74 offen offset:1664 sc1
    buffer_load_dword v31, v8, s[36:39], s75 offen offset:1664 sc1
    ds_read_b128 v[104:107], v1 offset:24576
    ds_read_b128 v[108:111], v1 offset:25600
    s_waitcnt vmcnt(0)
    v_xor_b32 v44, s40, v24
    v_bitop3_b32 v44, v44, v25, s40 bitop3:0xf6
    v_bitop3_b32 v44, v44, v26, s40 bitop3:0xf6
    v_bitop3_b32 v44, v44, v27, s40 bitop3:0xf6
    v_bitop3_b32 v44, v44, v28, s40 bitop3:0xf6
    v_bitop3_b32 v44, v44, v29, s40 bitop3:0xf6
    v_bitop3_b32 v44, v44, v30, s40 bitop3:0xf6
    v_bitop3_b32 v44, v44, v31, s40 bitop3:0xf6
    v_cmp_ne_u32 vcc, 0, v44
    s_nop 0
    s_and_b64 vcc, vcc, s[64:65]
    s_cbranch_scc1 L_rt_14
L_ok_15:
    v_mfma_f32_16x16x32_bf16 v[32:35], v[88:91], v[24:27], 0
    v_mfma_f32_16x16x32_bf16 v[36:39], v[92:95], v[24:27], 0
    v_mfma_f32_16x16x32_bf16 v[40:43], v[88:91], v[28:31], 0
    v_mfma_f32_16x16x32_bf16 v[44:47], v[92:95], v[28:31], 0
    s_mov_b32 exec_hi, 0xffff
    s_add_u32 s3, s49, 196608
    buffer_store_dwordx4 v[200:203], v1, s[36:39], s3 offen sc1
    s_add_u32 s3, s49, 294912
    buffer_store_dwordx4 v[200:203], v1, s[36:39], s3 offen sc1
    s_mov_b32 exec_hi, -1
    s_cmp_eq_u32 s41, 7
    s_cbranch_scc0 L_sk_16
    s_lshl_b32 s68, s2, 7
    s_add_u32 s68, s68, 131072
    buffer_store_dword v84, v23, s[36:39], s68 offen sc1
L_sk_16:
    buffer_load_dwordx4 v[248:251], v20, s[36:39], s70 offen sc1
    buffer_load_dwordx4 v[252:255], v21, s[36:39], s71 offen sc1
    v_pk_mul_f32 v[72:73], v[32:33], v[48:49] op_sel:[0,0] op_sel_hi:[1,0]
    v_pk_mul_f32 v[74:75], v[34:35], v[50:51] op_sel:[0,0] op_sel_hi:[1,0]
    v_pk_mul_f32 v[76:77], v[36:37], v[52:53] op_sel:[0,0] op_sel_hi:[1,0]
    v_pk_mul_f32 v[78:79], v[38:39], v[54:55] op_sel:[0,0] op_sel_hi:[1,0]
    v_pk_fma_f32 v[32:33], v[32:33], v[48:49], v[72:73] op_sel:[1,1,0] op_sel_hi:[0,1,1] neg_hi:[1,0,0]
    v_pk_fma_f32 v[34:35], v[34:35], v[50:51], v[74:75] op_sel:[1,1,0] op_sel_hi:[0,1,1] neg_hi:[1,0,0]
    v_pk_fma_f32 v[36:37], v[36:37], v[52:53], v[76:77] op_sel:[1,1,0] op_sel_hi:[0,1,1] neg_hi:[1,0,0]
    v_pk_fma_f32 v[38:39], v[38:39], v[54:55], v[78:79] op_sel:[1,1,0] op_sel_hi:[0,1,1] neg_hi:[1,0,0]
    v_pk_mul_f32 v[72:73], v[40:41], v[56:57] op_sel:[0,0] op_sel_hi:[1,0]
    v_pk_mul_f32 v[74:75], v[42:43], v[58:59] op_sel:[0,0] op_sel_hi:[1,0]
    v_pk_mul_f32 v[76:77], v[44:45], v[60:61] op_sel:[0,0] op_sel_hi:[1,0]
    v_pk_mul_f32 v[78:79], v[46:47], v[62:63] op_sel:[0,0] op_sel_hi:[1,0]
    v_pk_fma_f32 v[40:41], v[40:41], v[56:57], v[72:73] op_sel:[1,1,0] op_sel_hi:[0,1,1] neg_hi:[1,0,0]
    v_pk_fma_f32 v[42:43], v[42:43], v[58:59], v[74:75] op_sel:[1,1,0] op_sel_hi:[0,1,1] neg_hi:[1,0,0]
    v_pk_fma_f32 v[44:45], v[44:45], v[60:61], v[76:77] op_sel:[1,1,0] op_sel_hi:[0,1,1] neg_hi:[1,0,0]
    v_pk_fma_f32 v[46:47], v[46:47], v[62:63], v[78:79] op_sel:[1,1,0] op_sel_hi:[0,1,1] neg_hi:[1,0,0]
    v_cvt_pk_bf16_f32 v64, v32, v33
    v_cvt_pk_bf16_f32 v65, v40, v41
    ds_write_b64 v15, v[64:65] offset:16384
    v_cvt_pk_bf16_f32 v66, v34, v35
    v_cvt_pk_bf16_f32 v67, v42, v43
    ds_write_b64 v15, v[66:67] offset:17408
    v_cvt_pk_bf16_f32 v68, v36, v37
    v_cvt_pk_bf16_f32 v69, v44, v45
    ds_write_b64 v15, v[68:69] offset:24576
    v_cvt_pk_bf16_f32 v70, v38, v39
    v_cvt_pk_bf16_f32 v71, v46, v47
    ds_write_b64 v15, v[70:71] offset:25600
    s_waitcnt lgkmcnt(0)
    s_barrier
    ds_read_b128 v[24:27], v16 offset:16384
    ds_read_b128 v[28:31], v16 offset:17408
    s_waitcnt lgkmcnt(0)
    v_mfma_f32_16x16x32_bf16 v[32:35], v[88:91], v[24:27], 0
    v_mfma_f32_16x16x32_bf16 v[36:39], v[92:95], v[24:27], 0
    v_mfma_f32_16x16x32_bf16 v[40:43], v[88:91], v[28:31], 0
    v_mfma_f32_16x16x32_bf16 v[44:47], v[92:95], v[28:31], 0
    s_nop 4
    v_pk_mul_f32 v[72:73], v[32:33], v[112:113] op_sel:[0,0] op_sel_hi:[1,0]
    v_pk_mul_f32 v[74:75], v[34:35], v[114:115] op_sel:[0,0] op_sel_hi:[1,0]
    v_pk_mul_f32 v[76:77], v[36:37], v[116:117] op_sel:[0,0] op_sel_hi:[1,0]
    v_pk_mul_f32 v[78:79], v[38:39], v[118:119] op_sel:[0,0] op_sel_hi:[1,0]
    v_pk_fma_f32 v[32:33], v[32:33], v[112:113], v[72:73] op_sel:[1,1,0] op_sel_hi:[0,1,1] neg_lo:[1,0,0]
    v_pk_fma_f32 v[34:35], v[34:35], v[114:115], v[74:75] op_sel:[1,1,0] op_sel_hi:[0,1,1] neg_lo:[1,0,0]
    v_pk_fma_f32 v[36:37], v[36:37], v[116:117], v[76:77] op_sel:[1,1,0] op_sel_hi:[0,1,1] neg_lo:[1,0,0]
    v_pk_fma_f32 v[38:39], v[38:39], v[118:119], v[78:79] op_sel:[1,1,0] op_sel_hi:[0,1,1] neg_lo:[1,0,0]
    v_pk_mul_f32 v[72:73], v[40:41], v[120:121] op_sel:[0,0] op_sel_hi:[1,0]
    v_pk_mul_f32 v[74:75], v[42:43], v[122:123] op_sel:[0,0] op_sel_hi:[1,0]
    v_pk_mul_f32 v[76:77], v[44:45], v[124:125] op_sel:[0,0] op_sel_hi:[1,0]
    v_pk_mul_f32 v[78:79], v[46:47], v[126:127] op_sel:[0,0] op_sel_hi:[1,0]
    v_pk_fma_f32 v[40:41], v[40:41], v[120:121], v[72:73] op_sel:[1,1,0] op_sel_hi:[0,1,1] neg_lo:[1,0,0]
    v_pk_fma_f32 v[42:43], v[42:43], v[122:123], v[74:75] op_sel:[1,1,0] op_sel_hi:[0,1,1] neg_lo:[1,0,0]
    v_pk_fma_f32 v[44:45], v[44:45], v[124:125], v[76:77] op_sel:[1,1,0] op_sel_hi:[0,1,1] neg_lo:[1,0,0]
    v_pk_fma_f32 v[46:47], v[46:47], v[126:127], v[78:79] op_sel:[1,1,0] op_sel_hi:[0,1,1] neg_lo:[1,0,0]
    v_cvt_pk_bf16_f32 v24, v32, v33
    v_cvt_pk_bf16_f32 v25, v34, v35
    v_cvt_pk_bf16_f32 v26, v36, v37
    v_cvt_pk_bf16_f32 v27, v38, v39
    v_cvt_pk_bf16_f32 v28, v40, v41
    v_cvt_pk_bf16_f32 v29, v42, v43
    v_cvt_pk_bf16_f32 v30, v44, v45
    v_cvt_pk_bf16_f32 v31, v46, v47
    v_mfma_f32_16x16x32_bf16 v[32:35], v[96:99], v[24:27], 0
    v_mfma_f32_16x16x32_bf16 v[36:39], v[100:103], v[24:27], 0
    v_mfma_f32_16x16x32_bf16 v[40:43], v[96:99], v[28:31], 0
    v_mfma_f32_16x16x32_bf16 v[44:47], v[100:103], v[28:31], 0
    s_waitcnt vmcnt(0)
    v_xor_b32 v83, s40, v249
    v_bitop3_b32 v83, v83, v251, s40 bitop3:0xf6
    v_bitop3_b32 v83, v83, v253, s40 bitop3:0xf6
    v_bitop3_b32 v83, v83, v255, s40 bitop3:0xf6
    v_cmp_ne_u32 vcc, 0, v83
    s_cbranch_vccnz L_rt_17
L_ok_18:
    v_mov_b32 v249, v250
    v_mov_b32 v253, v254
    v_lshrrev_b32 v20, 1, v20
    v_lshrrev_b32 v21, 1, v21
    ds_write_b64 v20, v[248:249] offset:2560
    ds_write_b64 v21, v[252:253] offset:6656
    v_pk_mul_f32 v[72:73], v[32:33], v[48:49] op_sel:[0,0] op_sel_hi:[1,0]
    v_pk_mul_f32 v[74:75], v[34:35], v[50:51] op_sel:[0,0] op_sel_hi:[1,0]
    v_pk_mul_f32 v[76:77], v[36:37], v[52:53] op_sel:[0,0] op_sel_hi:[1,0]
    v_pk_mul_f32 v[78:79], v[38:39], v[54:55] op_sel:[0,0] op_sel_hi:[1,0]
    v_pk_fma_f32 v[32:33], v[32:33], v[48:49], v[72:73] op_sel:[1,1,0] op_sel_hi:[0,1,1] neg_lo:[1,0,0]
    v_pk_fma_f32 v[34:35], v[34:35], v[50:51], v[74:75] op_sel:[1,1,0] op_sel_hi:[0,1,1] neg_lo:[1,0,0]
    v_pk_fma_f32 v[36:37], v[36:37], v[52:53], v[76:77] op_sel:[1,1,0] op_sel_hi:[0,1,1] neg_lo:[1,0,0]
    v_pk_fma_f32 v[38:39], v[38:39], v[54:55], v[78:79] op_sel:[1,1,0] op_sel_hi:[0,1,1] neg_lo:[1,0,0]
    v_pk_mul_f32 v[72:73], v[40:41], v[56:57] op_sel:[0,0] op_sel_hi:[1,0]
    v_pk_mul_f32 v[74:75], v[42:43], v[58:59] op_sel:[0,0] op_sel_hi:[1,0]
    v_pk_mul_f32 v[76:77], v[44:45], v[60:61] op_sel:[0,0] op_sel_hi:[1,0]
    v_pk_mul_f32 v[78:79], v[46:47], v[62:63] op_sel:[0,0] op_sel_hi:[1,0]
    v_pk_fma_f32 v[40:41], v[40:41], v[56:57], v[72:73] op_sel:[1,1,0] op_sel_hi:[0,1,1] neg_lo:[1,0,0]
    v_pk_fma_f32 v[42:43], v[42:43], v[58:59], v[74:75] op_sel:[1,1,0] op_sel_hi:[0,1,1] neg_lo:[1,0,0]
    v_pk_fma_f32 v[44:45], v[44:45], v[60:61], v[76:77] op_sel:[1,1,0] op_sel_hi:[0,1,1] neg_lo:[1,0,0]
    v_pk_fma_f32 v[46:47], v[46:47], v[62:63], v[78:79] op_sel:[1,1,0] op_sel_hi:[0,1,1] neg_lo:[1,0,0]
    v_cvt_pk_bf16_f32 v64, v32, v33
    v_cvt_pk_bf16_f32 v65, v40, v41
    ds_write_b64 v15, v[64:65] offset:0
    v_cvt_pk_bf16_f32 v66, v34, v35
    v_cvt_pk_bf16_f32 v67, v42, v43
    ds_write_b64 v15, v[66:67] offset:1024
    v_cvt_pk_bf16_f32 v68, v36, v37
    v_cvt_pk_bf16_f32 v69, v44, v45
    ds_write_b64 v15, v[68:69] offset:8192
    v_cvt_pk_bf16_f32 v70, v38, v39
    v_cvt_pk_bf16_f32 v71, v46, v47
    ds_write_b64 v15, v[70:71] offset:9216
    s_waitcnt lgkmcnt(0)
    s_barrier
    ds_read_b128 v[24:27], v16 offset:0
    ds_read_b128 v[28:31], v16 offset:1024
    s_waitcnt lgkmcnt(0)
    v_mfma_f32_16x16x32_bf16 v[32:35], v[104:107], v[24:27], 0
    v_mfma_f32_16x16x32_bf16 v[36:39], v[108:111], v[24:27], 0
    v_mfma_f32_16x16x32_bf16 v[40:43], v[104:107], v[28:31], 0
    v_mfma_f32_16x16x32_bf16 v[44:47], v[108:111], v[28:31], 0
    s_cmp_eq_u32 s41, 7
    s_cbranch_scc0 L_sk_19
    s_lshl_b32 s68, s2, 7
    s_add_u32 s68, s68, 163840
    buffer_store_dword v84, v23, s[36:39], s68 offen sc1
L_sk_19:
    s_mov_b64 exec, s[66:67]
    s_nop 1
    v_cvt_pk_bf16_f32 v128, v32, v33
    v_cvt_pk_bf16_f32 v129, v34, v35
    v_cvt_pk_bf16_f32 v130, v36, v37
    v_cvt_pk_bf16_f32 v131, v38, v39
    v_cvt_pk_bf16_f32 v132, v40, v41
    v_cvt_pk_bf16_f32 v133, v42, v43
    v_cvt_pk_bf16_f32 v134, v44, v45
    v_cvt_pk_bf16_f32 v135, v46, v47
    s_mov_b64 exec, -1
    buffer_store_dword v128, v9, s[36:39], s72 offen offset:0 sc1
    buffer_store_dword v129, v9, s[36:39], s73 offen offset:0 sc1
    buffer_store_dword v130, v9, s[36:39], s78 offen offset:0 sc1
    buffer_store_dword v131, v9, s[36:39], s79 offen offset:0 sc1
    buffer_store_dword v132, v9, s[36:39], s72 offen offset:1664 sc1
    buffer_store_dword v133, v9, s[36:39], s73 offen offset:1664 sc1
    buffer_store_dword v134, v9, s[36:39], s78 offen offset:1664 sc1
    buffer_store_dword v135, v9, s[36:39], s79 offen offset:1664 sc1
    s_branch L_p3_13
L_nw_12:
    buffer_load_dwordx4 v[248:251], v20, s[36:39], s70 offen sc1
    buffer_load_dwordx4 v[252:255], v21, s[36:39], s71 offen sc1
    s_waitcnt vmcnt(0)
    v_xor_b32 v83, s40, v249
    v_bitop3_b32 v83, v83, v251, s40 bitop3:0xf6
    v_bitop3_b32 v83, v83, v253, s40 bitop3:0xf6
    v_bitop3_b32 v83, v83, v255, s40 bitop3:0xf6
    v_cmp_ne_u32 vcc, 0, v83
    s_cbranch_vccnz L_rt_20
L_ok_21:
    v_mov_b32 v249, v250
    v_mov_b32 v253, v254
    v_lshrrev_b32 v20, 1, v20
    v_lshrrev_b32 v21, 1, v21
    ds_write_b64 v20, v[248:249] offset:2560
    ds_write_b64 v21, v[252:253] offset:6656
    s_waitcnt vmcnt(0) lgkmcnt(0)
    s_barrier
    s_cmp_eq_u32 s41, 7
    s_cbranch_scc0 L_sk_22
    s_lshl_b32 s68, s2, 7
    s_add_u32 s68, s68, 131072
    buffer_store_dword v84, v23, s[36:39], s68 offen sc1
L_sk_22:
    s_mov_b32 exec_hi, 0xffff
    s_add_u32 s3, s49, 196608
    buffer_store_dwordx4 v[200:203], v1, s[36:39], s3 offen sc1
    s_add_u32 s3, s49, 294912
    buffer_store_dwordx4 v[200:203], v1, s[36:39], s3 offen sc1
    s_mov_b32 exec_hi, -1
L_p3_13:
    ds_read_b128 v[48:51], v1 offset:26624
    ds_read_b128 v[52:55], v1 offset:27648
    ds_read_b128 v[56:59], v1 offset:28672
    ds_read_b128 v[60:63], v1 offset:29696
    ds_read_b128 v[64:67], v1 offset:30720
    ds_read_b128 v[68:71], v1 offset:31744
    ds_read_b128 v[72:75], v1 offset:32768
    ds_read_b128 v[76:79], v1 offset:33792
    ds_read_b128 v[88:91], v1 offset:34816
    ds_read_b128 v[92:95], v1 offset:35840
    ds_read_b128 v[96:99], v1 offset:36864
    ds_read_b128 v[100:103], v1 offset:37888
    ds_read_b128 v[128:131], v1 offset:38912
    ds_read_b128 v[132:135], v1 offset:39936
    v_lshrrev_b32 v44, 1, v3
    v_lshl_add_u32 v45, v2, 1, 0
    v_lshl_add_u32 v44, v44, 8, s42
    v_mul_u32_u24 v44, v45, v44
    v_and_b32 v45, 1, v3
    v_mul_u32_u24 v45, 1536, v45
    v_add_u32 v44, v44, v45
    v_and_b32 v44, 2047, v44
    v_cvt_f32_u32 v44, v44
    v_mul_f32 v44, 0x3a000000, v44
    v_cos_f32 v46, v44
    v_sin_f32 v47, v44
    s_nop 0
    v_cvt_pk_bf16_f32 v18, v46, -v47
    v_lshrrev_b32 v44, 1, v3
    v_lshl_add_u32 v45, v2, 1, 1
    v_lshl_add_u32 v44, v44, 8, s42
    v_mul_u32_u24 v44, v45, v44
    v_and_b32 v45, 1, v3
    v_mul_u32_u24 v45, 1536, v45
    v_add_u32 v44, v44, v45
    v_and_b32 v44, 2047, v44
    v_cvt_f32_u32 v44, v44
    v_mul_f32 v44, 0x3a000000, v44
    v_cos_f32 v46, v44
    v_sin_f32 v47, v44
    s_nop 0
    v_cvt_pk_bf16_f32 v19, v46, -v47
    ds_read_b32 v24, v4 offset:2560
    ds_read_b32 v25, v4 offset:2624
    ds_read_b32 v26, v4 offset:2688
    ds_read_b32 v27, v4 offset:2752
    ds_read_b32 v28, v4 offset:2816
    ds_read_b32 v29, v4 offset:3840
    ds_read_b32 v30, v4 offset:3904
    ds_read_b32 v31, v4 offset:3968
    ds_read_b32 v32, v4 offset:4032
    ds_read_b32 v33, v4 offset:4096
    ds_read_b32 v34, v4 offset:5120
    ds_read_b32 v35, v4 offset:5184
    ds_read_b32 v36, v4 offset:5248
    ds_read_b32 v37, v4 offset:5312
    ds_read_b32 v38, v4 offset:5376
    v_lshlrev_b32 v238, 16, v10
    v_and_b32 v242, 0xffff0000, v10
    v_lshlrev_b32 v239, 16, v11
    v_and_b32 v243, 0xffff0000, v11
    v_lshlrev_b32 v240, 16, v12
    v_and_b32 v244, 0xffff0000, v12
    v_lshlrev_b32 v241, 16, v13
    v_and_b32 v245, 0xffff0000, v13
    v_lshlrev_b32 v246, 16, v14
    v_and_b32 v247, 0xffff0000, v14
    v_subrev_f32 v238, s61, v238
    v_subrev_f32 v239, s61, v239
    v_subrev_f32 v240, s61, v240
    v_subrev_f32 v241, s61, v241
    v_subrev_f32 v242, s61, v242
    v_subrev_f32 v243, s61, v243
    v_subrev_f32 v244, s61, v244
    v_subrev_f32 v245, s61, v245
    v_subrev_f32 v246, s61, v246
    v_subrev_f32 v247, s61, v247
    s_waitcnt lgkmcnt(0)
    v_lshlrev_b32 v104, 16, v24
    v_and_b32 v108, 0xffff0000, v24
    v_lshlrev_b32 v105, 16, v25
    v_and_b32 v109, 0xffff0000, v25
    v_lshlrev_b32 v106, 16, v26
    v_and_b32 v110, 0xffff0000, v26
    v_lshlrev_b32 v107, 16, v27
    v_and_b32 v111, 0xffff0000, v27
    v_lshlrev_b32 v112, 16, v28
    v_and_b32 v113, 0xffff0000, v28
    v_lshlrev_b32 v114, 16, v29
    v_and_b32 v118, 0xffff0000, v29
    v_lshlrev_b32 v115, 16, v30
    v_and_b32 v119, 0xffff0000, v30
    v_lshlrev_b32 v116, 16, v31
    v_and_b32 v120, 0xffff0000, v31
    v_lshlrev_b32 v117, 16, v32
    v_and_b32 v121, 0xffff0000, v32
    v_lshlrev_b32 v122, 16, v33
    v_and_b32 v123, 0xffff0000, v33
    v_lshlrev_b32 v228, 16, v34
    v_and_b32 v232, 0xffff0000, v34
    v_lshlrev_b32 v229, 16, v35
    v_and_b32 v233, 0xffff0000, v35
    v_lshlrev_b32 v230, 16, v36
    v_and_b32 v234, 0xffff0000, v36
    v_lshlrev_b32 v231, 16, v37
    v_and_b32 v235, 0xffff0000, v37
    v_lshlrev_b32 v236, 16, v38
    v_and_b32 v237, 0xffff0000, v38
    v_mov_b32_dpp v124, v132 quad_perm:[1,0,2,3] row_mask:0xf bank_mask:0xf
    v_mov_b32_dpp v125, v133 quad_perm:[1,0,2,3] row_mask:0xf bank_mask:0xf
    v_mov_b32_dpp v126, v134 quad_perm:[1,0,2,3] row_mask:0xf bank_mask:0xf
    v_mov_b32_dpp v127, v135 quad_perm:[1,0,2,3] row_mask:0xf bank_mask:0xf
    v_mul_u32_u24 v20, 2752, v2
    v_lshl_add_u32 v20, v85, 2, v20
    s_mul_i32 s68, s41, 56
    s_add_u32 s68, s68, 57344
    v_add_u32 v20, s68, v20
    v_mov_b32 v21, 68608
    v_cndmask_b32 v20, v20, v21, s[64:65]
    s_mul_i32 s68, s41, 1376
    s_add_u32 s68, s68, 57344
    v_add_u32 v21, s68, v4
    s_add_u32 s68, s68, 1040
    v_sub_u32 v22, s68, v4
    s_lshl_b32 s72, s42, 3
    s_add_u32 s72, s72, s41
    s_lshr_b32 s73, s72, 2
    s_sub_u32 s73, 0, s73
    s_and_b32 s73, s73, 3
    s_lshl_b32 s73, s73, 4
    v_lshlrev_b32 v15, 2, v3
    v_xor_b32 v15, s73, v15
    v_mul_u32_u24 v16, 40960, v2
    v_add_u32 v15, v15, v16
    s_lshl_b32 s74, s41, 6
    s_add_u32 s74, s74, s52
    s_mul_i32 s73, s41, 425984
    s_add_u32 s73, s73, s44
    s_sub_u32 s81, s48, 23
    s_min_u32 s81, s81, s48
    s_cmp_eq_u32 s41, 0
    s_cbranch_scc0 L_sk_23
    s_lshl_b32 s80, s81, 10
    s_add_u32 s80, s80, 163840
    v_lshlrev_b32 v33, 7, v0
    s_mov_b64 exec, 255
    buffer_load_dword v32, v33, s[36:39], s80 offen sc1
    s_waitcnt vmcnt(0)
    v_cmp_ne_u32 vcc, s40, v32
    s_cbranch_vccnz L_rt_24
L_ok_25:
    s_mov_b64 exec, -1
L_sk_23:
    s_waitcnt vmcnt(0)
    s_barrier
    buffer_load_dword v24, v6, s[36:39], s44 offen offset:0 sc1
    buffer_load_dword v25, v7, s[36:39], s44 offen offset:0 sc1
    buffer_load_dword v26, v6, s[36:39], s44 offen offset:512 sc1
    buffer_load_dword v27, v7, s[36:39], s44 offen offset:512 sc1
    buffer_load_dword v28, v6, s[36:39], s59 offen offset:512 sc1
    buffer_load_dword v29, v7, s[36:39], s59 offen offset:512 sc1
    s_mov_b32 exec_hi, 0
    buffer_load_dword v87, v17, s[36:39], s76 offen sc1
    s_mov_b32 exec_hi, -1
    s_waitcnt vmcnt(1)
    v_xor_b32 v44, s45, v24
    v_bitop3_b32 v44, v44, v25, s45 bitop3:0xf6
    v_bitop3_b32 v44, v44, v26, s45 bitop3:0xf6
    v_bitop3_b32 v44, v44, v27, s45 bitop3:0xf6
    v_bitop3_b32 v44, v44, v28, s45 bitop3:0xf6
    v_bitop3_b32 v44, v44, v29, s45 bitop3:0xf6
    v_cmp_ne_u32 vcc, 0, v44
    s_nop 0
    s_and_b64 vcc, vcc, s[64:65]
    s_cbranch_scc1 L_rt_26
L_ok_27:
    v_mfma_f32_16x16x16_bf16 v[32:35], v[18:19], v[24:25], 0
    v_mfma_f32_16x16x16_bf16 v[36:39], v[18:19], v[26:27], 0
    v_mfma_f32_16x16x16_bf16 v[40:43], v[18:19], v[28:29], 0
    s_nop 5
    v_cvt_pk_bf16_f32 v24, v32, v33
    ds_write_b32 v20, v24 offset:0
    v_cvt_pk_bf16_f32 v25, v34, v35
    ds_write_b32 v20, v25 offset:1376
    v_cvt_pk_bf16_f32 v26, v36, v37
    ds_write_b32 v20, v26 offset:448
    v_cvt_pk_bf16_f32 v27, v38, v39
    ds_write_b32 v20, v27 offset:1824
    v_cvt_pk_bf16_f32 v28, v40, v41
    ds_write_b32 v20, v28 offset:896
    v_cvt_pk_bf16_f32 v29, v42, v43
    ds_write_b32 v20, v29 offset:2272
    s_waitcnt lgkmcnt(0)
    s_barrier
    ds_read2_b32 v[24:25], v21 offset0:0 offset1:20
    ds_read2_b32 v[26:27], v21 offset0:40 offset1:60
    ds_read2_b32 v[28:29], v22 offset0:60 offset1:40
    ds_read2_b32 v[30:31], v22 offset0:20 offset1:0
    s_waitcnt vmcnt(0)
    v_cmp_ne_u32 vcc, s40, v87
    s_cbranch_vccnz L_rt_28
L_ok_29:
    buffer_load_dwordx4 v[136:139], v1, s[36:39], s54 offen offset:0 sc1
    buffer_load_dwordx4 v[140:143], v1, s[36:39], s54 offen offset:1024 sc1
    buffer_load_dwordx4 v[144:147], v1, s[36:39], s54 offen offset:2048 sc1
    s_add_u32 s54, s54, s8
    buffer_load_dwordx4 v[148:151], v1, s[36:39], s54 offen offset:0 sc1
    buffer_load_dwordx4 v[152:155], v1, s[36:39], s54 offen offset:1024 sc1
    buffer_load_dwordx4 v[156:159], v1, s[36:39], s54 offen offset:2048 sc1
    s_add_u32 s54, s54, s9
    s_waitcnt lgkmcnt(2)
    v_mfma_f32_16x16x32_bf16 v[32:35], v[24:27], v[48:51], 0
    v_mfma_f32_16x16x32_bf16 v[40:43], v[24:27], v[52:55], 0
    v_mfma_f32_16x16x32_bf16 v[36:39], v[24:27], v[56:59], 0
    v_mfma_f32_16x16x32_bf16 v[44:47], v[24:27], v[60:63], 0
    s_waitcnt lgkmcnt(0)
    v_mfma_f32_16x16x32_bf16 v[32:35], v[28:31], v[64:67], v[32:35]
    v_mfma_f32_16x16x32_bf16 v[40:43], v[28:31], v[68:71], v[40:43]
    v_mfma_f32_16x16x32_bf16 v[36:39], v[28:31], v[72:75], v[36:39]
    v_mfma_f32_16x16x32_bf16 v[44:47], v[28:31], v[76:79], v[44:47]
    s_nop 4
    v_pk_mul_f32 v[48:49], v[32:33], v[88:89]
    v_pk_mul_f32 v[56:57], v[40:41], v[88:89]
    v_pk_mul_f32 v[50:51], v[34:35], v[90:91]
    v_pk_mul_f32 v[58:59], v[42:43], v[90:91]
    v_pk_mul_f32 v[52:53], v[36:37], v[92:93]
    v_pk_mul_f32 v[60:61], v[44:45], v[92:93]
    v_pk_mul_f32 v[54:55], v[38:39], v[94:95]
    v_pk_mul_f32 v[62:63], v[46:47], v[94:95]
    v_pk_fma_f32 v[48:49], v[40:41], v[96:97], v[48:49] neg_lo:[1,0,0] neg_hi:[1,0,0]
    v_pk_fma_f32 v[56:57], v[32:33], v[96:97], v[56:57]
    v_pk_fma_f32 v[50:51], v[42:43], v[98:99], v[50:51] neg_lo:[1,0,0] neg_hi:[1,0,0]
    v_pk_fma_f32 v[58:59], v[34:35], v[98:99], v[58:59]
    v_pk_fma_f32 v[52:53], v[44:45], v[100:101], v[52:53] neg_lo:[1,0,0] neg_hi:[1,0,0]
    v_pk_fma_f32 v[60:61], v[36:37], v[100:101], v[60:61]
    v_pk_fma_f32 v[54:55], v[46:47], v[102:103], v[54:55] neg_lo:[1,0,0] neg_hi:[1,0,0]
    v_pk_fma_f32 v[62:63], v[38:39], v[102:103], v[62:63]
    v_cvt_pk_bf16_f32 v24, v48, v56
    v_cvt_pk_bf16_f32 v25, v49, v57
    v_cvt_pk_bf16_f32 v26, v50, v58
    v_cvt_pk_bf16_f32 v27, v51, v59
    v_cvt_pk_bf16_f32 v28, v52, v60
    v_cvt_pk_bf16_f32 v29, v53, v61
    v_cvt_pk_bf16_f32 v30, v54, v62
    v_cvt_pk_bf16_f32 v31, v55, v63
    v_mfma_f32_16x16x32_bf16 v[40:43], v[132:135], v[24:27], 0
    v_mfma_f32_16x16x32_bf16 v[32:35], v[128:131], v[24:27], 0
    v_mfma_f32_16x16x32_bf16 v[36:39], v[128:131], v[28:31], 0
    v_mfma_f32_16x16x32_bf16 v[40:43], v[124:127], v[28:31], v[40:43]
    s_add_u32 s88, s74, 8192
    s_add_u32 s89, s74, 16384
    s_add_u32 s90, s74, 24576
    s_add_u32 s91, s74, 32768
    s_nop 1
    v_pk_fma_f32 v[238:239], v[104:105], v[32:33], v[238:239]
    v_pk_fma_f32 v[240:241], v[106:107], v[34:35], v[240:241]
    v_pk_fma_f32 v[242:243], v[108:109], v[36:37], v[242:243]
    v_pk_fma_f32 v[244:245], v[110:111], v[38:39], v[244:245]
    v_pk_fma_f32 v[246:247], v[112:113], v[40:41], v[246:247]
    v_pk_add_f32 v[44:45], v[238:239], v[240:241]
    v_pk_mul_f32 v[46:47], v[238:239], v[238:239]
    v_pk_fma_f32 v[46:47], v[240:241], v[240:241], v[46:47]
    v_pk_add_f32 v[44:45], v[44:45], v[242:243]
    v_pk_fma_f32 v[46:47], v[242:243], v[242:243], v[46:47]
    v_pk_add_f32 v[44:45], v[44:45], v[244:245]
    v_pk_fma_f32 v[46:47], v[244:245], v[244:245], v[46:47]
    v_pk_add_f32 v[44:45], v[44:45], v[246:247]
    v_pk_fma_f32 v[46:47], v[246:247], v[246:247], v[46:47]
    v_add_f32 v44, v44, v45
    v_add_f32 v46, v46, v47
    v_mov_b32 v45, 0x3acccccd
    v_add_f32_dpp v44, v44, v44 quad_perm:[1,0,3,2] row_mask:0xf bank_mask:0xf
    v_add_f32_dpp v46, v46, v46 quad_perm:[1,0,3,2] row_mask:0xf bank_mask:0xf
    s_nop 0
    v_add_f32_dpp v44, v44, v44 quad_perm:[2,3,0,1] row_mask:0xf bank_mask:0xf
    v_add_f32_dpp v46, v46, v46 quad_perm:[2,3,0,1] row_mask:0xf bank_mask:0xf
    s_nop 0
    v_add_f32_dpp v44, v44, v44 row_ror:4 row_mask:0xf bank_mask:0xf
    v_add_f32_dpp v46, v46, v46 row_ror:4 row_mask:0xf bank_mask:0xf
    s_nop 0
    v_add_f32_dpp v44, v44, v44 row_ror:8 row_mask:0xf bank_mask:0xf
    v_add_f32_dpp v46, v46, v46 row_ror:8 row_mask:0xf bank_mask:0xf
    s_nop 0
    v_add_f32_dpp v44, v44, v44 row_bcast:15 row_mask:0xa bank_mask:0xf
    v_add_f32_dpp v46, v46, v46 row_bcast:15 row_mask:0xa bank_mask:0xf
    s_nop 0
    v_add_f32_dpp v44, v44, v44 row_bcast:31 row_mask:0xc bank_mask:0xf
    v_add_f32_dpp v46, v46, v46 row_bcast:31 row_mask:0xc bank_mask:0xf
    v_readlane_b32 s68, v44, 63
    v_readlane_b32 s69, v46, 63
    s_nop 0
    v_mul_f32 v44, s68, v45
    v_mul_f32 v46, s69, v45
    v_fma_f32 v46, -v44, v44, v46
    v_max_f32 v46, 0, v46
    v_add_f32 v46, 0x3727c5ac, v46
    v_rsq_f32 v46, v46
    s_nop 0
    v_mul_f32 v47, v44, v46
    v_pk_fma_f32 v[64:65], v[238:239], v[46:47], v[46:47] op_sel:[0,0,1] op_sel_hi:[1,0,1] neg_lo:[0,0,1] neg_hi:[0,0,1]
    v_pk_fma_f32 v[66:67], v[240:241], v[46:47], v[46:47] op_sel:[0,0,1] op_sel_hi:[1,0,1] neg_lo:[0,0,1] neg_hi:[0,0,1]
    v_pk_fma_f32 v[68:69], v[242:243], v[46:47], v[46:47] op_sel:[0,0,1] op_sel_hi:[1,0,1] neg_lo:[0,0,1] neg_hi:[0,0,1]
    v_pk_fma_f32 v[70:71], v[244:245], v[46:47], v[46:47] op_sel:[0,0,1] op_sel_hi:[1,0,1] neg_lo:[0,0,1] neg_hi:[0,0,1]
    v_pk_fma_f32 v[72:73], v[246:247], v[46:47], v[46:47] op_sel:[0,0,1] op_sel_hi:[1,0,1] neg_lo:[0,0,1] neg_hi:[0,0,1]
    v_pk_fma_f32 v[64:65], v[64:65], v[228:229], v[114:115]
    v_pk_fma_f32 v[66:67], v[66:67], v[230:231], v[116:117]
    v_pk_fma_f32 v[68:69], v[68:69], v[232:233], v[118:119]
    v_pk_fma_f32 v[70:71], v[70:71], v[234:235], v[120:121]
    v_pk_fma_f32 v[72:73], v[72:73], v[236:237], v[122:123]
    v_cvt_pk_bf16_f32 v24, v64, v68
    buffer_store_dword v24, v15, s[36:39], s74 offen sc1
    v_cvt_pk_bf16_f32 v25, v65, v69
    buffer_store_dword v25, v15, s[36:39], s88 offen sc1
    v_cvt_pk_bf16_f32 v26, v66, v70
    buffer_store_dword v26, v15, s[36:39], s89 offen sc1
    v_cvt_pk_bf16_f32 v27, v67, v71
    buffer_store_dword v27, v15, s[36:39], s90 offen sc1
    v_cvt_pk_bf16_f32 v28, v72, v73
    buffer_store_dword v28, v15, s[36:39], s91 offen sc1
    v_add_f32 v238, s61, v238
    v_add_f32 v239, s61, v239
    v_add_f32 v240, s61, v240
    v_add_f32 v241, s61, v241
    v_add_f32 v242, s61, v242
    v_add_f32 v243, s61, v243
    v_add_f32 v244, s61, v244
    v_add_f32 v245, s61, v245
    v_add_f32 v246, s61, v246
    v_add_f32 v247, s61, v247
    v_cvt_pk_bf16_f32 v10, v238, v242
    v_cvt_pk_bf16_f32 v11, v239, v243
    v_cvt_pk_bf16_f32 v12, v240, v244
    v_cvt_pk_bf16_f32 v13, v241, v245
    v_cvt_pk_bf16_f32 v14, v246, v247
    s_barrier
    buffer_store_dword v10, v4, s[36:39], s73 offen offset:0 sc1
    buffer_store_dword v11, v4, s[36:39], s73 offen offset:64 sc1
    buffer_store_dword v12, v4, s[36:39], s73 offen offset:128 sc1
    buffer_store_dword v13, v4, s[36:39], s73 offen offset:192 sc1
    buffer_store_dword v14, v4, s[36:39], s73 offen offset:256 sc1
    s_cmp_eq_u32 s2, 0
    s_cbranch_scc0 L_sk_30
    s_cmp_eq_u32 s41, 0
    s_cbranch_scc0 L_sk_31
    buffer_store_dword v87, v23, s[36:39], 0 offen sc1
L_sk_31:
L_sk_30:
    s_lshr_b32 s72, s41, 2
    s_and_b32 s73, s41, 3
    s_mul_i32 s68, s50, 163840
    s_mul_i32 s69, s72, 81920
    s_add_u32 s68, s68, s69
    s_lshl_b32 s69, s73, 11
    s_add_u32 s68, s68, s69
    s_lshl_b32 s69, s62, 13
    s_sub_u32 s70, s68, s69
    s_add_u32 s68, s68, s69
    s_add_u32 s84, s68, 4718592
    s_add_u32 s85, s70, 4726784
    s_add_u32 s86, s68, 4734976
    s_add_u32 s87, s70, 4743168
    s_add_u32 s88, s68, 4751360
    s_add_u32 s89, s70, 4759552
    s_add_u32 s90, s68, 4767744
    s_add_u32 s91, s70, 4775936
    s_add_u32 s92, s68, 4784128
    s_add_u32 s93, s70, 4792320
    s_lshl_b32 s78, s41, 11
    s_add_u32 s78, s78, 8192
    s_mul_i32 s68, s41, 3072
    v_add_u32 v7, s68, v1
    s_xor_b32 s68, s41, 4
    s_mul_i32 s68, s68, 3072
    v_add_u32 v8, s68, v1
    v_lshrrev_b32 v48, 1, v2
    v_and_b32 v49, 1, v2
    v_lshlrev_b32 v9, 4, v3
    v_lshl_add_u32 v9, v49, 3, v9
    v_add_u32 v9, s68, v9
    v_lshl_add_u32 v10, v48, 2, v9
    v_lshl_add_u32 v9, v48, 8, v9
    v_and_b32 v48, v48, v49
    v_lshl_add_u32 v14, v48, 30, v1
    v_bfe_u32 v48, v0, 1, 4
    v_and_b32 v49, 31, v0
    v_lshlrev_b32 v49, 6, v49
    v_lshl_add_u32 v16, v48, 2, v49
    v_add_u32 v16, s78, v16
    v_add_u32 v17, 65536, v16
    v_lshrrev_b32 v48, 2, v3
    v_sub_u32 v48, 0, v48
    v_and_b32 v48, 3, v48
    v_xor_b32 v48, v48, v2
    v_lshlrev_b32 v48, 4, v48
    v_lshl_add_u32 v48, v3, 6, v48
    s_mul_i32 s68, s72, 9216
    s_add_u32 s68, s68, 8192
    s_mul_i32 s69, s72, 7168
    s_add_u32 s69, s69, 9216
    v_add_u32 v2, s68, v48
    v_add_u32 v4, s69, v48
    v_add_u32 v3, 65536, v2
    v_add_u32 v6, 65536, v4
    s_lshl_b32 s77, s50, 3
    s_lshr_b32 s68, s51, 3
    s_add_u32 s77, s77, s68
    s_mul_i32 s79, s77, 49152
    s_mul_i32 s69, s41, 6144
    s_add_u32 s79, s79, s69
    s_lshl_b32 s69, s63, 10
    s_sub_u32 s12, s79, s69
    s_add_u32 s79, s79, s69
    s_cmp_ge_u32 s41, 4
    s_cbranch_scc0 L_sk_32
    s_setprio 1
L_sk_32:
    s_waitcnt vmcnt(0)
    s_barrier
    s_add_u32 m0, s78, 0
    s_nop 0
    buffer_load_dwordx4 v1, s[36:39], s84 offen offset:0 sc1 lds
    buffer_load_dwordx4 v1, s[36:39], s84 offen offset:1024 sc1 lds
    s_add_u32 m0, s78, 16384
    s_nop 0
    buffer_load_dwordx4 v1, s[36:39], s85 offen offset:0 sc1 lds
    buffer_load_dwordx4 v1, s[36:39], s85 offen offset:1024 sc1 lds
    s_waitcnt vmcnt(2)
    ds_read_b32 v18, v16 offset:0
    s_waitcnt lgkmcnt(0)
    v_cmp_eq_u32 vcc, -1, v18
    s_cbranch_vccnz L_rt_34
L_ok_33:
    s_barrier
    ds_read_b128 v[128:131], v2 offset:0
    ds_read_b128 v[132:135], v4 offset:0
    ds_read_b128 v[248:251], v2 offset:2048
    s_waitcnt lgkmcnt(2)
    v_mfma_f32_16x16x32_bf16 v[20:23], v[136:139], v[128:131], 0
    ds_read_b128 v[252:255], v4 offset:2048
    v_mfma_f32_16x16x32_bf16 v[24:27], v[140:143], v[128:131], 0
    s_add_u32 m0, s78, 32768
    s_nop 0
    buffer_load_dwordx4 v1, s[36:39], s86 offen offset:0 sc1 lds
    v_mfma_f32_16x16x32_bf16 v[28:31], v[144:147], v[128:131], 0
    s_waitcnt lgkmcnt(2)
    v_mfma_f32_16x16x32_bf16 v[32:35], v[136:139], v[132:135], 0
    ds_read_b128 v[128:131], v2 offset:4096
    v_mfma_f32_16x16x32_bf16 v[36:39], v[140:143], v[132:135], 0
    buffer_load_dwordx4 v1, s[36:39], s86 offen offset:1024 sc1 lds
    v_mfma_f32_16x16x32_bf16 v[40:43], v[144:147], v[132:135], 0
    s_waitcnt lgkmcnt(2)
    v_mfma_f32_16x16x32_bf16 v[44:47], v[136:139], v[248:251], 0
    ds_read_b128 v[132:135], v4 offset:4096
    v_mfma_f32_16x16x32_bf16 v[48:51], v[140:143], v[248:251], 0
    s_waitcnt vmcnt(2)
    ds_read_b32 v18, v16 offset:16384
    v_mfma_f32_16x16x32_bf16 v[52:55], v[144:147], v[248:251], 0
    buffer_load_dwordx4 v[160:163], v1, s[36:39], s54 offen offset:0 sc1
    s_waitcnt lgkmcnt(3)
    v_mfma_f32_16x16x32_bf16 v[56:59], v[136:139], v[252:255], 0
    ds_read_b128 v[248:251], v2 offset:6144
    v_mfma_f32_16x16x32_bf16 v[60:63], v[140:143], v[252:255], 0
    v_mfma_f32_16x16x32_bf16 v[64:67], v[144:147], v[252:255], 0
    s_waitcnt lgkmcnt(1)
    v_cmp_eq_u32 vcc, -1, v18
    v_mfma_f32_16x16x32_bf16 v[68:71], v[136:139], v[128:131], 0
    ds_read_b128 v[252:255], v4 offset:6144
    buffer_load_dwordx4 v[164:167], v1, s[36:39], s54 offen offset:1024 sc1
    v_mfma_f32_16x16x32_bf16 v[72:75], v[140:143], v[128:131], 0
    s_cbranch_vccnz L_rt_36
L_ok_35:
    v_mfma_f32_16x16x32_bf16 v[76:79], v[144:147], v[128:131], 0
    s_barrier
    v_mfma_f32_16x16x32_bf16 v[80:83], v[136:139], v[132:135], 0
    ds_read_b128 v[128:131], v2 offset:16384
    v_mfma_f32_16x16x32_bf16 v[84:87], v[140:143], v[132:135], 0
    buffer_load_dwordx4 v[168:171], v1, s[36:39], s54 offen offset:2048 sc1
    s_add_u32 s54, s54, s8
    v_mfma_f32_16x16x32_bf16 v[88:91], v[144:147], v[132:135], 0
    s_waitcnt lgkmcnt(2)
    v_mfma_f32_16x16x32_bf16 v[92:95], v[136:139], v[248:251], 0
    ds_read_b128 v[132:135], v4 offset:16384
    v_mfma_f32_16x16x32_bf16 v[96:99], v[140:143], v[248:251], 0
    v_mfma_f32_16x16x32_bf16 v[100:103], v[144:147], v[248:251], 0
    s_add_u32 m0, s78, 49152
    s_nop 0
    buffer_load_dwordx4 v1, s[36:39], s87 offen offset:0 sc1 lds
    s_waitcnt lgkmcnt(2)
    v_mfma_f32_16x16x32_bf16 v[104:107], v[136:139], v[252:255], 0
    ds_read_b128 v[248:251], v2 offset:18432
    v_mfma_f32_16x16x32_bf16 v[108:111], v[140:143], v[252:255], 0
    v_mfma_f32_16x16x32_bf16 v[112:115], v[144:147], v[252:255], 0
    buffer_load_dwordx4 v1, s[36:39], s87 offen offset:1024 sc1 lds
    s_waitcnt lgkmcnt(2)
    v_mfma_f32_16x16x32_bf16 v[20:23], v[148:151], v[128:131], v[20:23]
    ds_read_b128 v[252:255], v4 offset:18432
    v_mfma_f32_16x16x32_bf16 v[24:27], v[152:155], v[128:131], v[24:27]
    v_mfma_f32_16x16x32_bf16 v[28:31], v[156:159], v[128:131], v[28:31]
    s_waitcnt lgkmcnt(2)
    v_mfma_f32_16x16x32_bf16 v[32:35], v[148:151], v[132:135], v[32:35]
    ds_read_b128 v[128:131], v2 offset:20480
    buffer_load_dwordx4 v[172:175], v1, s[36:39], s54 offen offset:0 sc1
    v_mfma_f32_16x16x32_bf16 v[36:39], v[152:155], v[132:135], v[36:39]
    v_mfma_f32_16x16x32_bf16 v[40:43], v[156:159], v[132:135], v[40:43]
    s_waitcnt lgkmcnt(2)
    v_mfma_f32_16x16x32_bf16 v[44:47], v[148:151], v[248:251], v[44:47]
    ds_read_b128 v[132:135], v4 offset:20480
    v_mfma_f32_16x16x32_bf16 v[48:51], v[152:155], v[248:251], v[48:51]
    s_waitcnt vmcnt(6)
    ds_read_b32 v18, v16 offset:32768
    buffer_load_dwordx4 v[176:179], v1, s[36:39], s54 offen offset:1024 sc1
    v_mfma_f32_16x16x32_bf16 v[52:55], v[156:159], v[248:251], v[52:55]
    s_waitcnt lgkmcnt(3)
    v_mfma_f32_16x16x32_bf16 v[56:59], v[148:151], v[252:255], v[56:59]
    ds_read_b128 v[248:251], v2 offset:22528
    v_mfma_f32_16x16x32_bf16 v[60:63], v[152:155], v[252:255], v[60:63]
    v_mfma_f32_16x16x32_bf16 v[64:67], v[156:159], v[252:255], v[64:67]
    s_waitcnt lgkmcnt(1)
    v_cmp_eq_u32 vcc, -1, v18
    buffer_load_dwordx4 v[180:183], v1, s[36:39], s54 offen offset:2048 sc1
    s_add_u32 s54, s54, s9
    v_mfma_f32_16x16x32_bf16 v[68:71], v[148:151], v[128:131], v[68:71]
    ds_read_b128 v[252:255], v4 offset:22528
    v_mfma_f32_16x16x32_bf16 v[72:75], v[152:155], v[128:131], v[72:75]
    s_cbranch_vccnz L_rt_38
L_ok_37:
    v_mfma_f32_16x16x32_bf16 v[76:79], v[156:159], v[128:131], v[76:79]
    s_barrier
    v_mfma_f32_16x16x32_bf16 v[80:83], v[148:151], v[132:135], v[80:83]
    ds_read_b128 v[128:131], v2 offset:32768
    s_add_u32 m0, s78, 65536
    s_nop 0
    buffer_load_dwordx4 v1, s[36:39], s88 offen offset:0 sc1 lds
    v_mfma_f32_16x16x32_bf16 v[84:87], v[152:155], v[132:135], v[84:87]
    v_mfma_f32_16x16x32_bf16 v[88:91], v[156:159], v[132:135], v[88:91]
    s_waitcnt lgkmcnt(2)
    v_mfma_f32_16x16x32_bf16 v[92:95], v[148:151], v[248:251], v[92:95]
    ds_read_b128 v[132:135], v4 offset:32768
    buffer_load_dwordx4 v1, s[36:39], s88 offen offset:1024 sc1 lds
    v_mfma_f32_16x16x32_bf16 v[96:99], v[152:155], v[248:251], v[96:99]
    v_mfma_f32_16x16x32_bf16 v[100:103], v[156:159], v[248:251], v[100:103]
    s_waitcnt lgkmcnt(2)
    v_mfma_f32_16x16x32_bf16 v[104:107], v[148:151], v[252:255], v[104:107]
    ds_read_b128 v[248:251], v2 offset:34816
    v_mfma_f32_16x16x32_bf16 v[108:111], v[152:155], v[252:255], v[108:111]
    s_add_u32 m0, s78, 81920
    s_nop 0
    buffer_load_dwordx4 v1, s[36:39], s89 offen offset:0 sc1 lds
    v_mfma_f32_16x16x32_bf16 v[112:115], v[156:159], v[252:255], v[112:115]
    s_waitcnt vmcnt(8)
    s_waitcnt lgkmcnt(2)
    v_mfma_f32_16x16x32_bf16 v[20:23], v[160:163], v[128:131], v[20:23]
    ds_read_b128 v[252:255], v4 offset:34816
    v_mfma_f32_16x16x32_bf16 v[24:27], v[164:167], v[128:131], v[24:27]
    v_mfma_f32_16x16x32_bf16 v[28:31], v[168:171], v[128:131], v[28:31]
    buffer_load_dwordx4 v1, s[36:39], s89 offen offset:1024 sc1 lds
    s_waitcnt lgkmcnt(2)
    v_mfma_f32_16x16x32_bf16 v[32:35], v[160:163], v[132:135], v[32:35]
    ds_read_b128 v[128:131], v2 offset:36864
    v_mfma_f32_16x16x32_bf16 v[36:39], v[164:167], v[132:135], v[36:39]
    v_mfma_f32_16x16x32_bf16 v[40:43], v[168:171], v[132:135], v[40:43]
    s_waitcnt lgkmcnt(2)
    v_mfma_f32_16x16x32_bf16 v[44:47], v[160:163], v[248:251], v[44:47]
    ds_read_b128 v[132:135], v4 offset:36864
    buffer_load_dwordx4 v[136:139], v1, s[36:39], s54 offen offset:0 sc1
    v_mfma_f32_16x16x32_bf16 v[48:51], v[164:167], v[248:251], v[48:51]
    s_waitcnt vmcnt(8)
    ds_read_b32 v18, v16 offset:49152
    v_mfma_f32_16x16x32_bf16 v[52:55], v[168:171], v[248:251], v[52:55]
    s_waitcnt lgkmcnt(3)
    v_mfma_f32_16x16x32_bf16 v[56:59], v[160:163], v[252:255], v[56:59]
    ds_read_b128 v[248:251], v2 offset:38912
    buffer_load_dwordx4 v[140:143], v1, s[36:39], s54 offen offset:1024 sc1
    v_mfma_f32_16x16x32_bf16 v[60:63], v[164:167], v[252:255], v[60:63]
    v_mfma_f32_16x16x32_bf16 v[64:67], v[168:171], v[252:255], v[64:67]
    s_waitcnt lgkmcnt(1)
    v_cmp_eq_u32 vcc, -1, v18
    v_mfma_f32_16x16x32_bf16 v[68:71], v[160:163], v[128:131], v[68:71]
    ds_read_b128 v[252:255], v4 offset:38912
    v_mfma_f32_16x16x32_bf16 v[72:75], v[164:167], v[128:131], v[72:75]
    s_cbranch_vccnz L_rt_40
L_ok_39:
    buffer_load_dwordx4 v[144:147], v1, s[36:39], s54 offen offset:2048 sc1
    s_add_u32 s54, s54, s8
    v_mfma_f32_16x16x32_bf16 v[76:79], v[168:171], v[128:131], v[76:79]
    s_barrier
    v_mfma_f32_16x16x32_bf16 v[80:83], v[160:163], v[132:135], v[80:83]
    ds_read_b128 v[128:131], v2 offset:49152
    v_mfma_f32_16x16x32_bf16 v[84:87], v[164:167], v[132:135], v[84:87]
    v_mfma_f32_16x16x32_bf16 v[88:91], v[168:171], v[132:135], v[88:91]
    s_add_u32 m0, s78, 98304
    s_nop 0
    buffer_load_dwordx4 v1, s[36:39], s90 offen offset:0 sc1 lds
    s_waitcnt lgkmcnt(2)
    v_mfma_f32_16x16x32_bf16 v[92:95], v[160:163], v[248:251], v[92:95]
    ds_read_b128 v[132:135], v4 offset:49152
    v_mfma_f32_16x16x32_bf16 v[96:99], v[164:167], v[248:251], v[96:99]
    v_mfma_f32_16x16x32_bf16 v[100:103], v[168:171], v[248:251], v[100:103]
    s_waitcnt lgkmcnt(2)
    v_mfma_f32_16x16x32_bf16 v[104:107], v[160:163], v[252:255], v[104:107]
    ds_read_b128 v[248:251], v2 offset:51200
    buffer_load_dwordx4 v1, s[36:39], s90 offen offset:1024 sc1 lds
    v_mfma_f32_16x16x32_bf16 v[108:111], v[164:167], v[252:255], v[108:111]
    v_mfma_f32_16x16x32_bf16 v[112:115], v[168:171], v[252:255], v[112:115]
    s_waitcnt vmcnt(9)
    s_waitcnt lgkmcnt(2)
    v_mfma_f32_16x16x32_bf16 v[20:23], v[172:175], v[128:131], v[20:23]
    ds_read_b128 v[252:255], v4 offset:51200
    v_mfma_f32_16x16x32_bf16 v[24:27], v[176:179], v[128:131], v[24:27]
    s_add_u32 m0, s78, 114688
    s_nop 0
    buffer_load_dwordx4 v1, s[36:39], s91 offen offset:0 sc1 lds
    v_mfma_f32_16x16x32_bf16 v[28:31], v[180:183], v[128:131], v[28:31]
    s_waitcnt lgkmcnt(2)
    v_mfma_f32_16x16x32_bf16 v[32:35], v[172:175], v[132:135], v[32:35]
    ds_read_b128 v[128:131], v2 offset:53248
    v_mfma_f32_16x16x32_bf16 v[36:39], v[176:179], v[132:135], v[36:39]
    buffer_load_dwordx4 v1, s[36:39], s91 offen offset:1024 sc1 lds
    v_mfma_f32_16x16x32_bf16 v[40:43], v[180:183], v[132:135], v[40:43]
    s_waitcnt lgkmcnt(2)
    v_mfma_f32_16x16x32_bf16 v[44:47], v[172:175], v[248:251], v[44:47]
    ds_read_b128 v[132:135], v4 offset:53248
    v_mfma_f32_16x16x32_bf16 v[48:51], v[176:179], v[248:251], v[48:51]
    s_waitcnt vmcnt(9)
    ds_read_b32 v18, v17 offset:0
    v_mfma_f32_16x16x32_bf16 v[52:55], v[180:183], v[248:251], v[52:55]
    buffer_load_dwordx4 v[148:151], v1, s[36:39], s54 offen offset:0 sc1
    s_waitcnt lgkmcnt(3)
    v_mfma_f32_16x16x32_bf16 v[56:59], v[172:175], v[252:255], v[56:59]
    ds_read_b128 v[248:251], v2 offset:55296
    v_mfma_f32_16x16x32_bf16 v[60:63], v[176:179], v[252:255], v[60:63]
    v_mfma_f32_16x16x32_bf16 v[64:67], v[180:183], v[252:255], v[64:67]
    s_waitcnt lgkmcnt(1)
    v_cmp_eq_u32 vcc, -1, v18
    v_mfma_f32_16x16x32_bf16 v[68:71], v[172:175], v[128:131], v[68:71]
    ds_read_b128 v[252:255], v4 offset:55296
    buffer_load_dwordx4 v[152:155], v1, s[36:39], s54 offen offset:1024 sc1
    v_mfma_f32_16x16x32_bf16 v[72:75], v[176:179], v[128:131], v[72:75]
    s_cbranch_vccnz L_rt_42
L_ok_41:
    v_mfma_f32_16x16x32_bf16 v[76:79], v[180:183], v[128:131], v[76:79]
    s_barrier
    v_mfma_f32_16x16x32_bf16 v[80:83], v[172:175], v[132:135], v[80:83]
    ds_read_b128 v[128:131], v3 offset:0
    v_mfma_f32_16x16x32_bf16 v[84:87], v[176:179], v[132:135], v[84:87]
    buffer_load_dwordx4 v[156:159], v1, s[36:39], s54 offen offset:2048 sc1
    s_add_u32 s54, s54, s9
    v_mfma_f32_16x16x32_bf16 v[88:91], v[180:183], v[132:135], v[88:91]
    s_waitcnt lgkmcnt(2)
    v_mfma_f32_16x16x32_bf16 v[92:95], v[172:175], v[248:251], v[92:95]
    ds_read_b128 v[132:135], v6 offset:0
    v_mfma_f32_16x16x32_bf16 v[96:99], v[176:179], v[248:251], v[96:99]
    v_mfma_f32_16x16x32_bf16 v[100:103], v[180:183], v[248:251], v[100:103]
    s_add_u32 m0, s78, 0
    s_nop 0
    buffer_load_dwordx4 v1, s[36:39], s92 offen offset:0 sc1 lds
    s_waitcnt lgkmcnt(2)
    v_mfma_f32_16x16x32_bf16 v[104:107], v[172:175], v[252:255], v[104:107]
    ds_read_b128 v[248:251], v3 offset:2048
    v_mfma_f32_16x16x32_bf16 v[108:111], v[176:179], v[252:255], v[108:111]
    v_mfma_f32_16x16x32_bf16 v[112:115], v[180:183], v[252:255], v[112:115]
    buffer_load_dwordx4 v1, s[36:39], s92 offen offset:1024 sc1 lds
    s_waitcnt vmcnt(9)
    s_waitcnt lgkmcnt(2)
    v_mfma_f32_16x16x32_bf16 v[20:23], v[136:139], v[128:131], v[20:23]
    ds_read_b128 v[252:255], v6 offset:2048
    ds_read_b32 v18, v17 offset:16384
    v_mfma_f32_16x16x32_bf16 v[24:27], v[140:143], v[128:131], v[24:27]
    v_mfma_f32_16x16x32_bf16 v[28:31], v[144:147], v[128:131], v[28:31]
    s_waitcnt lgkmcnt(3)
    v_mfma_f32_16x16x32_bf16 v[32:35], v[136:139], v[132:135], v[32:35]
    ds_read_b128 v[128:131], v3 offset:4096
    buffer_load_dwordx4 v[160:163], v1, s[36:39], s54 offen offset:0 sc1
    v_mfma_f32_16x16x32_bf16 v[36:39], v[140:143], v[132:135], v[36:39]
    s_waitcnt lgkmcnt(1)
    v_cmp_eq_u32 vcc, -1, v18
    v_mfma_f32_16x16x32_bf16 v[40:43], v[144:147], v[132:135], v[40:43]
    v_mfma_f32_16x16x32_bf16 v[44:47], v[136:139], v[248:251], v[44:47]
    ds_read_b128 v[132:135], v6 offset:4096
    s_cbranch_vccnz L_rt_44
L_ok_43:
    v_mfma_f32_16x16x32_bf16 v[48:51], v[140:143], v[248:251], v[48:51]
    s_waitcnt vmcnt(8)
    ds_read_b32 v18, v17 offset:32768
    buffer_load_dwordx4 v[164:167], v1, s[36:39], s54 offen offset:1024 sc1
    v_mfma_f32_16x16x32_bf16 v[52:55], v[144:147], v[248:251], v[52:55]
    v_mfma_f32_16x16x32_bf16 v[56:59], v[136:139], v[252:255], v[56:59]
    ds_read_b128 v[248:251], v3 offset:6144
    v_mfma_f32_16x16x32_bf16 v[60:63], v[140:143], v[252:255], v[60:63]
    v_mfma_f32_16x16x32_bf16 v[64:67], v[144:147], v[252:255], v[64:67]
    s_waitcnt lgkmcnt(1)
    v_cmp_eq_u32 vcc, -1, v18
    buffer_load_dwordx4 v[168:171], v1, s[36:39], s54 offen offset:2048 sc1
    s_add_u32 s54, s54, s8
    v_mfma_f32_16x16x32_bf16 v[68:71], v[136:139], v[128:131], v[68:71]
    ds_read_b128 v[252:255], v6 offset:6144
    v_mfma_f32_16x16x32_bf16 v[72:75], v[140:143], v[128:131], v[72:75]
    s_cbranch_vccnz L_rt_46
L_ok_45:
    v_mfma_f32_16x16x32_bf16 v[76:79], v[144:147], v[128:131], v[76:79]
    s_barrier
    v_mfma_f32_16x16x32_bf16 v[80:83], v[136:139], v[132:135], v[80:83]
    ds_read_b128 v[128:131], v3 offset:16384
    s_add_u32 m0, s78, 16384
    s_nop 0
    buffer_load_dwordx4 v1, s[36:39], s93 offen offset:0 sc1 lds
    v_mfma_f32_16x16x32_bf16 v[84:87], v[140:143], v[132:135], v[84:87]
    v_mfma_f32_16x16x32_bf16 v[88:91], v[144:147], v[132:135], v[88:91]
    s_waitcnt lgkmcnt(2)
    v_mfma_f32_16x16x32_bf16 v[92:95], v[136:139], v[248:251], v[92:95]
    ds_read_b128 v[132:135], v6 offset:16384
    buffer_load_dwordx4 v1, s[36:39], s93 offen offset:1024 sc1 lds
    v_mfma_f32_16x16x32_bf16 v[96:99], v[140:143], v[248:251], v[96:99]
    v_mfma_f32_16x16x32_bf16 v[100:103], v[144:147], v[248:251], v[100:103]
    s_waitcnt lgkmcnt(2)
    v_mfma_f32_16x16x32_bf16 v[104:107], v[136:139], v[252:255], v[104:107]
    ds_read_b128 v[248:251], v3 offset:18432
    v_mfma_f32_16x16x32_bf16 v[108:111], v[140:143], v[252:255], v[108:111]
    buffer_load_dwordx4 v[172:175], v1, s[36:39], s54 offen offset:0 sc1
    v_mfma_f32_16x16x32_bf16 v[112:115], v[144:147], v[252:255], v[112:115]
    s_waitcnt vmcnt(8)
    s_waitcnt lgkmcnt(2)
    v_mfma_f32_16x16x32_bf16 v[20:23], v[148:151], v[128:131], v[20:23]
    ds_read_b128 v[252:255], v6 offset:18432
    ds_read_b32 v18, v17 offset:49152
    v_mfma_f32_16x16x32_bf16 v[24:27], v[152:155], v[128:131], v[24:27]
    v_mfma_f32_16x16x32_bf16 v[28:31], v[156:159], v[128:131], v[28:31]
    buffer_load_dwordx4 v[176:179], v1, s[36:39], s54 offen offset:1024 sc1
    s_waitcnt lgkmcnt(3)
    v_mfma_f32_16x16x32_bf16 v[32:35], v[148:151], v[132:135], v[32:35]
    ds_read_b128 v[128:131], v3 offset:20480
    v_mfma_f32_16x16x32_bf16 v[36:39], v[152:155], v[132:135], v[36:39]
    s_waitcnt lgkmcnt(1)
    v_cmp_eq_u32 vcc, -1, v18
    v_mfma_f32_16x16x32_bf16 v[40:43], v[156:159], v[132:135], v[40:43]
    v_mfma_f32_16x16x32_bf16 v[44:47], v[148:151], v[248:251], v[44:47]
    ds_read_b128 v[132:135], v6 offset:20480
    s_cbranch_vccnz L_rt_48
L_ok_47:
    buffer_load_dwordx4 v[180:183], v1, s[36:39], s54 offen offset:2048 sc1
    s_add_u32 s54, s54, s9
    v_mfma_f32_16x16x32_bf16 v[48:51], v[152:155], v[248:251], v[48:51]
    s_waitcnt vmcnt(8)
    ds_read_b32 v18, v16 offset:0
    v_mfma_f32_16x16x32_bf16 v[52:55], v[156:159], v[248:251], v[52:55]
    v_mfma_f32_16x16x32_bf16 v[56:59], v[148:151], v[252:255], v[56:59]
    ds_read_b128 v[248:251], v3 offset:22528
    v_mfma_f32_16x16x32_bf16 v[60:63], v[152:155], v[252:255], v[60:63]
    buffer_load_dwordx4 v[136:139], v1, s[36:39], s54 offen offset:0 sc1
    v_mfma_f32_16x16x32_bf16 v[64:67], v[156:159], v[252:255], v[64:67]
    s_waitcnt lgkmcnt(1)
    v_cmp_eq_u32 vcc, -1, v18
    v_mfma_f32_16x16x32_bf16 v[68:71], v[148:151], v[128:131], v[68:71]
    ds_read_b128 v[252:255], v6 offset:22528
    v_mfma_f32_16x16x32_bf16 v[72:75], v[152:155], v[128:131], v[72:75]
    s_cbranch_vccnz L_rt_50
L_ok_49:
    buffer_load_dwordx4 v[140:143], v1, s[36:39], s54 offen offset:1024 sc1
    v_mfma_f32_16x16x32_bf16 v[76:79], v[156:159], v[128:131], v[76:79]
    s_barrier
    v_mfma_f32_16x16x32_bf16 v[80:83], v[148:151], v[132:135], v[80:83]
    ds_read_b128 v[128:131], v3 offset:32768
    v_mfma_f32_16x16x32_bf16 v[84:87], v[152:155], v[132:135], v[84:87]
    v_mfma_f32_16x16x32_bf16 v[88:91], v[156:159], v[132:135], v[88:91]
    buffer_load_dwordx4 v[144:147], v1, s[36:39], s54 offen offset:2048 sc1
    s_add_u32 s54, s54, s8
    s_waitcnt lgkmcnt(2)
    v_mfma_f32_16x16x32_bf16 v[92:95], v[148:151], v[248:251], v[92:95]
    ds_read_b128 v[132:135], v6 offset:32768
    v_mfma_f32_16x16x32_bf16 v[96:99], v[152:155], v[248:251], v[96:99]
    v_mfma_f32_16x16x32_bf16 v[100:103], v[156:159], v[248:251], v[100:103]
    s_waitcnt lgkmcnt(2)
    v_mfma_f32_16x16x32_bf16 v[104:107], v[148:151], v[252:255], v[104:107]
    ds_read_b128 v[248:251], v3 offset:34816
    buffer_load_dwordx4 v[184:187], v1, s[36:39], s55 offen offset:0 sc1
    v_mfma_f32_16x16x32_bf16 v[108:111], v[152:155], v[252:255], v[108:111]
    v_mfma_f32_16x16x32_bf16 v[112:115], v[156:159], v[252:255], v[112:115]
    s_waitcnt vmcnt(9)
    s_waitcnt lgkmcnt(2)
    v_mfma_f32_16x16x32_bf16 v[20:23], v[160:163], v[128:131], v[20:23]
    ds_read_b128 v[252:255], v6 offset:34816
    v_mfma_f32_16x16x32_bf16 v[24:27], v[164:167], v[128:131], v[24:27]
    buffer_load_dwordx4 v[148:151], v1, s[36:39], s54 offen offset:0 sc1
    v_mfma_f32_16x16x32_bf16 v[28:31], v[168:171], v[128:131], v[28:31]
    s_waitcnt lgkmcnt(2)
    v_mfma_f32_16x16x32_bf16 v[32:35], v[160:163], v[132:135], v[32:35]
    ds_read_b128 v[128:131], v3 offset:36864
    v_mfma_f32_16x16x32_bf16 v[36:39], v[164:167], v[132:135], v[36:39]
    v_mfma_f32_16x16x32_bf16 v[40:43], v[168:171], v[132:135], v[40:43]
    buffer_load_dwordx4 v[152:155], v1, s[36:39], s54 offen offset:1024 sc1
    s_waitcnt lgkmcnt(2)
    v_mfma_f32_16x16x32_bf16 v[44:47], v[160:163], v[248:251], v[44:47]
    ds_read_b128 v[132:135], v6 offset:36864
    v_mfma_f32_16x16x32_bf16 v[48:51], v[164:167], v[248:251], v[48:51]
    s_waitcnt vmcnt(9)
    ds_read_b32 v18, v16 offset:16384
    v_mfma_f32_16x16x32_bf16 v[52:55], v[168:171], v[248:251], v[52:55]
    s_waitcnt lgkmcnt(3)
    v_mfma_f32_16x16x32_bf16 v[56:59], v[160:163], v[252:255], v[56:59]
    ds_read_b128 v[248:251], v3 offset:38912
    buffer_load_dwordx4 v[156:159], v1, s[36:39], s54 offen offset:2048 sc1
    s_add_u32 s54, s54, s9
    v_mfma_f32_16x16x32_bf16 v[60:63], v[164:167], v[252:255], v[60:63]
    v_mfma_f32_16x16x32_bf16 v[64:67], v[168:171], v[252:255], v[64:67]
    s_waitcnt lgkmcnt(1)
    v_cmp_eq_u32 vcc, -1, v18
    v_mfma_f32_16x16x32_bf16 v[68:71], v[160:163], v[128:131], v[68:71]
    ds_read_b128 v[252:255], v6 offset:38912
    buffer_load_dwordx4 v[188:191], v1, s[36:39], s55 offen offset:1024 sc1
    v_mfma_f32_16x16x32_bf16 v[72:75], v[164:167], v[128:131], v[72:75]
    s_cbranch_vccnz L_rt_52
L_ok_51:
    v_mfma_f32_16x16x32_bf16 v[76:79], v[168:171], v[128:131], v[76:79]
    s_barrier
    v_mfma_f32_16x16x32_bf16 v[80:83], v[160:163], v[132:135], v[80:83]
    ds_read_b128 v[128:131], v3 offset:49152
    v_mfma_f32_16x16x32_bf16 v[84:87], v[164:167], v[132:135], v[84:87]
    buffer_load_dwordx4 v[192:195], v1, s[36:39], s55 offen offset:2048 sc1
    v_mfma_f32_16x16x32_bf16 v[88:91], v[168:171], v[132:135], v[88:91]
    s_waitcnt lgkmcnt(2)
    v_mfma_f32_16x16x32_bf16 v[92:95], v[160:163], v[248:251], v[92:95]
    ds_read_b128 v[132:135], v6 offset:49152
    v_mfma_f32_16x16x32_bf16 v[96:99], v[164:167], v[248:251], v[96:99]
    v_mfma_f32_16x16x32_bf16 v[100:103], v[168:171], v[248:251], v[100:103]
    buffer_load_dwordx4 v[196:199], v1, s[36:39], s55 offen offset:3072 sc1
    s_add_u32 s55, s55, 4096
    s_waitcnt lgkmcnt(2)
    v_mfma_f32_16x16x32_bf16 v[104:107], v[160:163], v[252:255], v[104:107]
    ds_read_b128 v[248:251], v2 offset:0
    v_mfma_f32_16x16x32_bf16 v[108:111], v[164:167], v[252:255], v[108:111]
    v_mfma_f32_16x16x32_bf16 v[112:115], v[168:171], v[252:255], v[112:115]
    s_waitcnt vmcnt(10)
    s_waitcnt lgkmcnt(2)
    v_mfma_f32_16x16x32_bf16 v[20:23], v[172:175], v[128:131], v[20:23]
    ds_read_b128 v[252:255], v4 offset:0
    buffer_load_dwordx4 v[200:203], v1, s[36:39], s55 offen offset:0 sc1
    s_add_u32 s55, s55, s10
    v_mfma_f32_16x16x32_bf16 v[24:27], v[176:179], v[128:131], v[24:27]
    v_mfma_f32_16x16x32_bf16 v[28:31], v[180:183], v[128:131], v[28:31]
    s_waitcnt lgkmcnt(2)
    v_mfma_f32_16x16x32_bf16 v[32:35], v[172:175], v[132:135], v[32:35]
    ds_read_b128 v[128:131], v4 offset:16384
    v_mfma_f32_16x16x32_bf16 v[36:39], v[176:179], v[132:135], v[36:39]
    buffer_load_dwordx4 v[204:207], v1, s[36:39], s55 offen offset:0 sc1
    v_mfma_f32_16x16x32_bf16 v[40:43], v[180:183], v[132:135], v[40:43]
    s_waitcnt vmcnt(9)
    s_waitcnt lgkmcnt(2)
    v_mfma_f32_16x16x32_bf16 v[20:23], v[136:139], v[248:251], v[20:23]
    ds_read_b128 v[132:135], v2 offset:16384
    v_mfma_f32_16x16x32_bf16 v[24:27], v[140:143], v[248:251], v[24:27]
    buffer_load_dwordx4 v[208:211], v1, s[36:39], s55 offen offset:1024 sc1
    v_mfma_f32_16x16x32_bf16 v[28:31], v[144:147], v[248:251], v[28:31]
    s_waitcnt lgkmcnt(2)
    v_mfma_f32_16x16x32_bf16 v[32:35], v[136:139], v[252:255], v[32:35]
    ds_read_b128 v[248:251], v3 offset:51200
    v_mfma_f32_16x16x32_bf16 v[36:39], v[140:143], v[252:255], v[36:39]
    v_mfma_f32_16x16x32_bf16 v[40:43], v[144:147], v[252:255], v[40:43]
    buffer_load_dwordx4 v[212:215], v1, s[36:39], s55 offen offset:2048 sc1
    s_waitcnt vmcnt(7)
    s_waitcnt lgkmcnt(2)
    v_mfma_f32_16x16x32_bf16 v[32:35], v[148:151], v[128:131], v[32:35]
    ds_read_b128 v[252:255], v6 offset:51200
    v_mfma_f32_16x16x32_bf16 v[36:39], v[152:155], v[128:131], v[36:39]
    v_mfma_f32_16x16x32_bf16 v[40:43], v[156:159], v[128:131], v[40:43]
    s_waitcnt lgkmcnt(2)
    v_mfma_f32_16x16x32_bf16 v[20:23], v[148:151], v[132:135], v[20:23]
    ds_read_b128 v[128:131], v2 offset:2048
    buffer_load_dwordx4 v[216:219], v1, s[36:39], s55 offen offset:3072 sc1
    s_add_u32 s55, s55, 4096
    v_mfma_f32_16x16x32_bf16 v[24:27], v[152:155], v[132:135], v[24:27]
    v_mfma_f32_16x16x32_bf16 v[28:31], v[156:159], v[132:135], v[28:31]
    v_add_u32 v19, 139264, v7
    s_waitcnt lgkmcnt(2)
    v_mfma_f32_16x16x32_bf16 v[44:47], v[172:175], v[248:251], v[44:47]
    ds_read_b128 v[132:135], v4 offset:2048
    ds_write_b128 v19, v[32:35] offset:0
    v_mfma_f32_16x16x32_bf16 v[48:51], v[176:179], v[248:251], v[48:51]
    ds_write_b128 v19, v[36:39] offset:1024
    buffer_load_dwordx4 v[220:223], v1, s[36:39], s55 offen offset:0 sc1
    s_add_u32 s55, s55, s11
    v_mfma_f32_16x16x32_bf16 v[52:55], v[180:183], v[248:251], v[52:55]
    ds_write_b128 v19, v[40:43] offset:2048
    s_waitcnt lgkmcnt(5)
    v_mfma_f32_16x16x32_bf16 v[56:59], v[172:175], v[252:255], v[56:59]
    ds_read_b128 v[248:251], v4 offset:18432
    v_mfma_f32_16x16x32_bf16 v[60:63], v[176:179], v[252:255], v[60:63]
    v_mfma_f32_16x16x32_bf16 v[64:67], v[180:183], v[252:255], v[64:67]
    s_waitcnt lgkmcnt(1)
    s_barrier
    v_add_u32 v11, 139264, v8
    ds_read_b128 v[40:43], v11 offset:2048
    buffer_load_dwordx4 v[224:227], v1, s[36:39], s55 offen offset:0 sc1
    v_mfma_f32_16x16x32_bf16 v[44:47], v[136:139], v[128:131], v[44:47]
    ds_read_b128 v[252:255], v2 offset:18432
    ds_read_b128 v[32:35], v11 offset:0
    ds_read_b128 v[36:39], v11 offset:1024
    v_mfma_f32_16x16x32_bf16 v[48:51], v[140:143], v[128:131], v[48:51]
    v_mfma_f32_16x16x32_bf16 v[52:55], v[144:147], v[128:131], v[52:55]
    buffer_load_dwordx4 v[228:231], v1, s[36:39], s55 offen offset:1024 sc1
    v_mfma_f32_16x16x32_bf16 v[56:59], v[136:139], v[132:135], v[56:59]
    ds_read_b128 v[128:131], v3 offset:53248
    s_waitcnt lgkmcnt(1)
    v_add_f32 v28, v28, v40
    v_add_f32 v29, v29, v41
    v_mfma_f32_16x16x32_bf16 v[60:63], v[140:143], v[132:135], v[60:63]
    v_add_f32 v30, v30, v42
    v_add_f32 v31, v31, v43
    v_add_f32 v20, v20, v32
    v_mfma_f32_16x16x32_bf16 v[64:67], v[144:147], v[132:135], v[64:67]
    v_add_f32 v21, v21, v33
    v_add_f32 v22, v22, v34
    v_add_f32 v23, v23, v35
    v_mfma_f32_16x16x32_bf16 v[56:59], v[148:151], v[248:251], v[56:59]
    ds_read_b128 v[132:135], v6 offset:53248
    v_add_f32 v24, v24, v36
    v_add_f32 v25, v25, v37
    v_add_f32 v26, v26, v38
    buffer_load_dwordx4 v[232:235], v1, s[36:39], s55 offen offset:2048 sc1
    v_mfma_f32_16x16x32_bf16 v[60:63], v[152:155], v[248:251], v[60:63]
    v_add_f32 v27, v27, v39
    v_permlane32_swap_b32 v28, v30
    v_permlane32_swap_b32 v29, v31
    v_mfma_f32_16x16x32_bf16 v[64:67], v[156:159], v[248:251], v[64:67]
    v_add_u32 v32, 139264, v9
    v_add_u32 v33, 139264, v10
    v_mul_f32 v20, v20, v24
    v_mfma_f32_16x16x32_bf16 v[44:47], v[148:151], v[252:255], v[44:47]
    ds_read_b128 v[248:251], v2 offset:4096
    v_mul_f32 v21, v21, v25
    v_mul_f32 v22, v22, v26
    v_mul_f32 v23, v23, v27
    v_mfma_f32_16x16x32_bf16 v[48:51], v[152:155], v[252:255], v[48:51]
    v_mul_f32 v28, v28, v30
    v_mul_f32 v29, v29, v31
    v_cvt_pk_bf16_f32 v34, v20, v21
    buffer_load_dwordx4 v[236:239], v1, s[36:39], s55 offen offset:3072 sc1
    s_add_u32 s55, s55, 4096
    v_mfma_f32_16x16x32_bf16 v[52:55], v[156:159], v[252:255], v[52:55]
    v_cvt_pk_bf16_f32 v35, v22, v23
    v_cvt_pk_bf16_f32 v36, v28, v29
    ds_write_b64 v32, v[34:35]
    v_add_u32 v19, 40960, v7
    s_waitcnt lgkmcnt(3)
    v_mfma_f32_16x16x32_bf16 v[68:71], v[172:175], v[128:131], v[68:71]
    ds_read_b128 v[252:255], v4 offset:4096
    ds_write_b32 v33, v36 offset:512
    ds_read_b128 v[40:43], v11
    ds_write_b128 v19, v[56:59] offset:0
    v_mfma_f32_16x16x32_bf16 v[72:75], v[176:179], v[128:131], v[72:75]
    ds_write_b128 v19, v[60:63] offset:1024
    v_mfma_f32_16x16x32_bf16 v[76:79], v[180:183], v[128:131], v[76:79]
    ds_write_b128 v19, v[64:67] offset:2048
    buffer_load_dwordx4 v[240:243], v1, s[36:39], s55 offen offset:0 sc1
    s_add_u32 s55, s55, s10
    s_waitcnt lgkmcnt(8)
    v_mfma_f32_16x16x32_bf16 v[80:83], v[172:175], v[132:135], v[80:83]
    ds_read_b128 v[128:131], v4 offset:20480
    v_mfma_f32_16x16x32_bf16 v[84:87], v[176:179], v[132:135], v[84:87]
    v_mfma_f32_16x16x32_bf16 v[88:91], v[180:183], v[132:135], v[88:91]
    s_waitcnt lgkmcnt(4)
    s_add_u32 s69, s49, 0
    buffer_store_dwordx4 v[40:43], v14, s[36:39], s69 offen sc1
    s_waitcnt lgkmcnt(1)
    s_barrier
    v_add_u32 v18, 40960, v8
    ds_read_b128 v[64:67], v18 offset:2048
    v_mfma_f32_16x16x32_bf16 v[68:71], v[136:139], v[248:251], v[68:71]
    ds_read_b128 v[132:135], v2 offset:20480
    ds_read_b128 v[56:59], v18 offset:0
    ds_read_b128 v[60:63], v18 offset:1024
    buffer_load_dwordx4 v[244:247], v1, s[36:39], s55 offen offset:0 sc1
    v_mfma_f32_16x16x32_bf16 v[72:75], v[140:143], v[248:251], v[72:75]
    v_mfma_f32_16x16x32_bf16 v[76:79], v[144:147], v[248:251], v[76:79]
    v_mfma_f32_16x16x32_bf16 v[80:83], v[136:139], v[252:255], v[80:83]
    ds_read_b128 v[248:251], v3 offset:55296
    s_waitcnt lgkmcnt(1)
    v_add_f32 v52, v52, v64
    v_add_f32 v53, v53, v65
    buffer_load_dwordx4 v[116:119], v1, s[36:39], s55 offen offset:1024 sc1
    v_mfma_f32_16x16x32_bf16 v[84:87], v[140:143], v[252:255], v[84:87]
    v_add_f32 v54, v54, v66
    v_add_f32 v55, v55, v67
    v_add_f32 v44, v44, v56
    v_mfma_f32_16x16x32_bf16 v[88:91], v[144:147], v[252:255], v[88:91]
    v_add_f32 v45, v45, v57
    v_add_f32 v46, v46, v58
    v_add_f32 v47, v47, v59
    v_mfma_f32_16x16x32_bf16 v[80:83], v[148:151], v[128:131], v[80:83]
    ds_read_b128 v[252:255], v6 offset:55296
    v_add_f32 v48, v48, v60
    v_add_f32 v49, v49, v61
    v_add_f32 v50, v50, v62
    v_mfma_f32_16x16x32_bf16 v[84:87], v[152:155], v[128:131], v[84:87]
    v_add_f32 v51, v51, v63
    v_permlane32_swap_b32 v52, v54
    v_permlane32_swap_b32 v53, v55
    buffer_load_dwordx4 v[120:123], v1, s[36:39], s55 offen offset:2048 sc1
    v_mfma_f32_16x16x32_bf16 v[88:91], v[156:159], v[128:131], v[88:91]
    v_add_u32 v56, 40960, v9
    v_add_u32 v57, 40960, v10
    v_mul_f32 v44, v44, v48
    v_mfma_f32_16x16x32_bf16 v[68:71], v[148:151], v[132:135], v[68:71]
    ds_read_b128 v[128:131], v2 offset:6144
    v_mul_f32 v45, v45, v49
    v_mul_f32 v46, v46, v50
    v_mul_f32 v47, v47, v51
    v_mfma_f32_16x16x32_bf16 v[72:75], v[152:155], v[132:135], v[72:75]
    v_mul_f32 v52, v52, v54
    v_mul_f32 v53, v53, v55
    v_cvt_pk_bf16_f32 v58, v44, v45
    v_mfma_f32_16x16x32_bf16 v[76:79], v[156:159], v[132:135], v[76:79]
    v_cvt_pk_bf16_f32 v59, v46, v47
    v_cvt_pk_bf16_f32 v60, v52, v53
    ds_write_b64 v56, v[58:59]
    v_add_u32 v19, 65536, v7
    buffer_load_dwordx4 v[124:127], v1, s[36:39], s55 offen offset:3072 sc1
    s_add_u32 s55, s55, 4096
    s_waitcnt lgkmcnt(3)
    v_mfma_f32_16x16x32_bf16 v[92:95], v[172:175], v[248:251], v[92:95]
    ds_read_b128 v[132:135], v4 offset:6144
    ds_write_b32 v57, v60 offset:512
    ds_read_b128 v[64:67], v18
    ds_write_b128 v19, v[80:83] offset:0
    v_mfma_f32_16x16x32_bf16 v[96:99], v[176:179], v[248:251], v[96:99]
    ds_write_b128 v19, v[84:87] offset:1024
    buffer_load_dwordx4 v[160:163], v1, s[36:39], s55 offen offset:0 sc1
    s_add_u32 s55, s55, s11
    v_mfma_f32_16x16x32_bf16 v[100:103], v[180:183], v[248:251], v[100:103]
    ds_write_b128 v19, v[88:91] offset:2048
    s_waitcnt lgkmcnt(8)
    v_mfma_f32_16x16x32_bf16 v[104:107], v[172:175], v[252:255], v[104:107]
    ds_read_b128 v[248:251], v4 offset:22528
    buffer_load_dwordx4 v[164:167], v1, s[36:39], s55 offen offset:0 sc1
    v_mfma_f32_16x16x32_bf16 v[108:111], v[176:179], v[252:255], v[108:111]
    v_mfma_f32_16x16x32_bf16 v[112:115], v[180:183], v[252:255], v[112:115]
    s_waitcnt lgkmcnt(4)
    s_add_u32 s69, s49, 98304
    buffer_store_dwordx4 v[64:67], v14, s[36:39], s69 offen sc1
    s_waitcnt lgkmcnt(1)
    s_barrier
    v_add_u32 v11, 65536, v8
    ds_read_b128 v[88:91], v11 offset:2048
    buffer_load_dwordx4 v[168:171], v1, s[36:39], s55 offen offset:1024 sc1
    v_mfma_f32_16x16x32_bf16 v[92:95], v[136:139], v[128:131], v[92:95]
    ds_read_b128 v[252:255], v2 offset:22528
    ds_read_b128 v[80:83], v11 offset:0
    ds_read_b128 v[84:87], v11 offset:1024
    v_mfma_f32_16x16x32_bf16 v[96:99], v[140:143], v[128:131], v[96:99]
    buffer_load_dwordx4 v[20:23], v1, s[36:39], s55 offen offset:2048 sc1
    v_mfma_f32_16x16x32_bf16 v[100:103], v[144:147], v[128:131], v[100:103]
    v_mfma_f32_16x16x32_bf16 v[104:107], v[136:139], v[132:135], v[104:107]
    s_waitcnt lgkmcnt(0)
    v_add_f32 v76, v76, v88
    v_add_f32 v77, v77, v89
    buffer_load_dwordx4 v[24:27], v1, s[36:39], s55 offen offset:3072 sc1
    s_add_u32 s55, s55, 4096
    v_mfma_f32_16x16x32_bf16 v[108:111], v[140:143], v[132:135], v[108:111]
    v_add_f32 v78, v78, v90
    v_add_f32 v79, v79, v91
    v_add_f32 v68, v68, v80
    v_mfma_f32_16x16x32_bf16 v[112:115], v[144:147], v[132:135], v[112:115]
    v_add_f32 v69, v69, v81
    v_add_f32 v70, v70, v82
    v_add_f32 v71, v71, v83
    buffer_load_dwordx4 v[28:31], v1, s[36:39], s55 offen offset:0 sc1
    s_add_u32 s55, s55, s10
    v_mfma_f32_16x16x32_bf16 v[104:107], v[148:151], v[248:251], v[104:107]
    v_add_f32 v72, v72, v84
    v_add_f32 v73, v73, v85
    v_add_f32 v74, v74, v86
    v_mfma_f32_16x16x32_bf16 v[108:111], v[152:155], v[248:251], v[108:111]
    v_add_f32 v75, v75, v87
    v_permlane32_swap_b32 v76, v78
    v_permlane32_swap_b32 v77, v79
    buffer_load_dwordx4 v[32:35], v1, s[36:39], s55 offen offset:0 sc1
    s_add_u32 s71, s79, 7340032
    buffer_load_dwordx4 v[172:175], v1, s[36:39], s71 offen sc1
    v_mfma_f32_16x16x32_bf16 v[112:115], v[156:159], v[248:251], v[112:115]
    v_add_u32 v80, 65536, v9
    v_add_u32 v81, 65536, v10
    v_mul_f32 v68, v68, v72
    s_add_u32 s71, s12, 7341056
    buffer_load_dwordx4 v[176:179], v1, s[36:39], s71 offen sc1
    v_mfma_f32_16x16x32_bf16 v[92:95], v[148:151], v[252:255], v[92:95]
    v_mul_f32 v69, v69, v73
    v_mul_f32 v70, v70, v74
    v_mul_f32 v71, v71, v75
    buffer_load_dwordx4 v[36:39], v1, s[36:39], s55 offen offset:1024 sc1
    s_add_u32 s71, s79, 7342080
    buffer_load_dwordx4 v[180:183], v1, s[36:39], s71 offen sc1
    v_mfma_f32_16x16x32_bf16 v[96:99], v[152:155], v[252:255], v[96:99]
    v_mul_f32 v76, v76, v78
    v_mul_f32 v77, v77, v79
    v_cvt_pk_bf16_f32 v82, v68, v69
    s_add_u32 s71, s12, 7343104
    buffer_load_dwordx4 v[136:139], v1, s[36:39], s71 offen sc1
    v_mfma_f32_16x16x32_bf16 v[100:103], v[156:159], v[252:255], v[100:103]
    v_cvt_pk_bf16_f32 v83, v70, v71
    v_cvt_pk_bf16_f32 v84, v76, v77
    ds_write_b64 v80, v[82:83]
    v_add_u32 v19, 98304, v7
    buffer_load_dwordx4 v[40:43], v1, s[36:39], s55 offen offset:2048 sc1
    s_add_u32 s71, s79, 7344128
    buffer_load_dwordx4 v[140:143], v1, s[36:39], s71 offen sc1
    ds_write_b32 v81, v84 offset:512
    ds_read_b128 v[88:91], v11
    ds_write_b128 v19, v[104:107] offset:0
    s_add_u32 s71, s12, 7345152
    buffer_load_dwordx4 v[144:147], v1, s[36:39], s71 offen sc1
    ds_write_b128 v19, v[108:111] offset:1024
    buffer_load_dwordx4 v[44:47], v1, s[36:39], s55 offen offset:3072 sc1
    s_add_u32 s55, s55, 4096
    ds_write_b128 v19, v[112:115] offset:2048
    buffer_load_dwordx4 v[48:51], v1, s[36:39], s55 offen offset:0 sc1
    s_add_u32 s55, s55, s11
    s_waitcnt lgkmcnt(3)
    s_add_u32 s69, s49, 196608
    buffer_store_dwordx4 v[88:91], v14, s[36:39], s69 offen sc1
    s_waitcnt lgkmcnt(0)
    s_barrier
    v_add_u32 v18, 98304, v8
    ds_read_b128 v[112:115], v18 offset:2048
    s_add_u32 s71, s79, 7438336
    buffer_load_dwordx4 v[148:151], v1, s[36:39], s71 offen sc1
    s_add_u32 s71, s12, 7439360
    buffer_load_dwordx4 v[152:155], v1, s[36:39], s71 offen sc1
    s_add_u32 s71, s79, 7440384
    buffer_load_dwordx4 v[156:159], v1, s[36:39], s71 offen sc1
    s_add_u32 s71, s12, 7441408
    buffer_load_dwordx4 v[52:55], v1, s[36:39], s71 offen sc1
    s_add_u32 s71, s79, 7442432
    buffer_load_dwordx4 v[56:59], v1, s[36:39], s71 offen sc1
    s_add_u32 s71, s12, 7443456
    buffer_load_dwordx4 v[60:63], v1, s[36:39], s71 offen sc1
    ds_read_b128 v[104:107], v18 offset:0
    ds_read_b128 v[108:111], v18 offset:1024
    s_waitcnt vmcnt(9)
    v_max3_u32 v13, v172, v176, v180
    v_max3_u32 v12, v136, v140, v144
    v_max_u32 v13, v13, v12
    v_cmp_eq_u32 vcc, -1, v13
    s_waitcnt lgkmcnt(0)
    v_add_f32 v100, v100, v112
    v_add_f32 v101, v101, v113
    s_cbranch_vccnz L_rt_54
L_ok_53:
    v_mfma_f32_16x16x32_bf16 v[128:131], v[184:187], v[172:175], 0
    v_add_f32 v102, v102, v114
    v_add_f32 v103, v103, v115
    v_add_f32 v92, v92, v104
    v_mfma_f32_16x16x32_bf16 v[132:135], v[188:191], v[172:175], 0
    v_add_f32 v93, v93, v105
    v_add_f32 v94, v94, v106
    v_add_f32 v95, v95, v107
    v_mfma_f32_16x16x32_bf16 v[248:251], v[192:195], v[172:175], 0
    v_add_f32 v96, v96, v108
    v_add_f32 v97, v97, v109
    v_add_f32 v98, v98, v110
    v_mfma_f32_16x16x32_bf16 v[252:255], v[196:199], v[172:175], 0
    v_add_f32 v99, v99, v111
    v_permlane32_swap_b32 v100, v102
    v_permlane32_swap_b32 v101, v103
    v_mfma_f32_16x16x32_bf16 v[64:67], v[200:203], v[172:175], 0
    v_add_u32 v104, 98304, v9
    v_add_u32 v105, 98304, v10
    v_mul_f32 v92, v92, v96
    v_mfma_f32_16x16x32_bf16 v[128:131], v[204:207], v[176:179], v[128:131]
    v_mul_f32 v93, v93, v97
    v_mul_f32 v94, v94, v98
    v_mul_f32 v95, v95, v99
    v_mfma_f32_16x16x32_bf16 v[132:135], v[208:211], v[176:179], v[132:135]
    v_mul_f32 v100, v100, v102
    v_mul_f32 v101, v101, v103
    v_cvt_pk_bf16_f32 v106, v92, v93
    v_mfma_f32_16x16x32_bf16 v[248:251], v[212:215], v[176:179], v[248:251]
    v_cvt_pk_bf16_f32 v107, v94, v95
    v_cvt_pk_bf16_f32 v108, v100, v101
    ds_write_b64 v104, v[106:107]
    v_mfma_f32_16x16x32_bf16 v[252:255], v[216:219], v[176:179], v[252:255]
    ds_write_b32 v105, v108 offset:512
    ds_read_b128 v[112:115], v18
    v_mfma_f32_16x16x32_bf16 v[64:67], v[220:223], v[176:179], v[64:67]
    v_mfma_f32_16x16x32_bf16 v[128:131], v[224:227], v[180:183], v[128:131]
    v_mfma_f32_16x16x32_bf16 v[132:135], v[228:231], v[180:183], v[132:135]
    v_mfma_f32_16x16x32_bf16 v[248:251], v[232:235], v[180:183], v[248:251]
    v_mfma_f32_16x16x32_bf16 v[252:255], v[236:239], v[180:183], v[252:255]
    s_waitcnt lgkmcnt(0)
    s_add_u32 s69, s49, 294912
    buffer_store_dwordx4 v[112:115], v14, s[36:39], s69 offen sc1
    v_mfma_f32_16x16x32_bf16 v[64:67], v[240:243], v[180:183], v[64:67]
    s_mul_i32 s68, s41, 2592
    s_add_u32 s68, s68, 8192
    v_lshrrev_b32 v2, 1, v1
    s_add_u32 s71, s79, 7536640
    buffer_load_dwordx4 v[68:71], v1, s[36:39], s71 offen sc1
    v_mfma_f32_16x16x32_bf16 v[128:131], v[244:247], v[136:139], v[128:131]
    v_add_u32 v2, s68, v2
    v_lshrrev_b32 v16, 8, v1
    v_bfe_u32 v17, v1, 4, 4
    s_add_u32 s71, s12, 7537664
    buffer_load_dwordx4 v[72:75], v1, s[36:39], s71 offen sc1
    v_mfma_f32_16x16x32_bf16 v[132:135], v[116:119], v[136:139], v[132:135]
    s_lshr_b32 s68, s41, 2
    s_and_b32 s69, s41, 3
    s_mul_i32 s70, s68, 1280
    s_add_u32 s71, s79, 7538688
    buffer_load_dwordx4 v[76:79], v1, s[36:39], s71 offen sc1
    v_mfma_f32_16x16x32_bf16 v[248:251], v[120:123], v[136:139], v[248:251]
    s_lshl_b32 s82, s69, 5
    s_add_u32 s70, s70, s82
    s_add_u32 s70, s70, 8192
    s_add_u32 s71, s12, 7539712
    buffer_load_dwordx4 v[80:83], v1, s[36:39], s71 offen sc1
    v_mfma_f32_16x16x32_bf16 v[252:255], v[124:127], v[136:139], v[252:255]
    v_lshrrev_b32 v3, 2, v17
    v_mul_u32_u24 v3, 2592, v3
    v_and_b32 v4, 3, v17
    s_add_u32 s71, s79, 7540736
    buffer_load_dwordx4 v[84:87], v1, s[36:39], s71 offen sc1
    v_mfma_f32_16x16x32_bf16 v[64:67], v[160:163], v[136:139], v[64:67]
    v_lshl_add_u32 v3, v4, 3, v3
    v_add_u32 v3, s70, v3
    v_and_b32 v4, 1, v16
    s_add_u32 s71, s12, 7541760
    buffer_load_dwordx4 v[88:91], v1, s[36:39], s71 offen sc1
    v_mfma_f32_16x16x32_bf16 v[128:131], v[164:167], v[140:143], v[128:131]
    v_lshl_add_u32 v7, v4, 7, v3
    v_lshl_add_u32 v3, v16, 7, v3
    v_sub_u32 v4, v17, v16
    v_mfma_f32_16x16x32_bf16 v[132:135], v[168:171], v[140:143], v[132:135]
    v_mov_b32 v6, 0x3f803f80
    v_cmp_eq_u32 s[82:83], 0, v4
    s_nop 1
    v_cndmask_b32 v92, 0, v6, s[82:83]
    v_mfma_f32_16x16x32_bf16 v[248:251], v[20:23], v[140:143], v[248:251]
    v_mov_b32 v93, v92
    v_mov_b32 v94, v92
    v_mov_b32 v95, v92
    v_mfma_f32_16x16x32_bf16 v[252:255], v[24:27], v[140:143], v[252:255]
    v_cmp_eq_u32 s[82:83], 4, v4
    s_nop 1
    v_cndmask_b32 v96, 0, v6, s[82:83]
    v_mov_b32 v97, v96
    v_mfma_f32_16x16x32_bf16 v[64:67], v[28:31], v[140:143], v[64:67]
    v_mov_b32 v98, v96
    v_mov_b32 v99, v96
    v_cmp_eq_u32 s[82:83], 8, v4
    s_waitcnt vmcnt(14)
    v_mfma_f32_16x16x32_bf16 v[128:131], v[32:35], v[144:147], v[128:131]
    v_cndmask_b32 v100, 0, v6, s[82:83]
    v_mov_b32 v101, v100
    v_mov_b32 v102, v100
    v_mfma_f32_16x16x32_bf16 v[132:135], v[36:39], v[144:147], v[132:135]
    v_mov_b32 v103, v100
    s_lshl_b32 s69, s69, 2
    v_add_u32 v16, s69, v16
    v_mfma_f32_16x16x32_bf16 v[248:251], v[40:43], v[144:147], v[248:251]
    v_cmp_lt_u32 s[82:83], 9, v17
    v_min_u32 v17, 9, v17
    s_mul_i32 s70, s53, 160
    s_waitcnt vmcnt(7)
    v_max3_u32 v13, v148, v152, v156
    v_max3_u32 v12, v52, v56, v60
    v_mfma_f32_16x16x32_bf16 v[252:255], v[44:47], v[144:147], v[252:255]
    s_mul_i32 s68, s68, 80
    s_add_u32 s70, s70, s68
    v_lshl_add_u32 v17, v17, 3, s70
    v_max_u32 v13, v13, v12
    v_cmp_eq_u32 vcc, -1, v13
    v_mfma_f32_16x16x32_bf16 v[64:67], v[48:51], v[144:147], v[64:67]
    v_and_b32 v4, 7, v16
    v_lshrrev_b32 v16, 3, v16
    v_lshl_add_u32 v16, v4, 8, v16
    s_cbranch_vccnz L_rt_56
L_ok_55:
    v_cvt_pk_bf16_f32 v108, v128, v129
    v_cvt_pk_bf16_f32 v109, v130, v131
    ds_write_b64 v2, v[108:109] offset:0
    v_mfma_f32_16x16x32_bf16 v[128:131], v[184:187], v[148:151], 0
    v_mul_u32_u24 v6, 1664, v16
    v_add_u32 v6, v6, v17
    v_mul_u32_u24 v4, 1280, v16
    v_cvt_pk_bf16_f32 v110, v132, v133
    v_cvt_pk_bf16_f32 v111, v134, v135
    ds_write_b64 v2, v[110:111] offset:512
    v_mfma_f32_16x16x32_bf16 v[132:135], v[188:191], v[148:151], 0
    v_add_u32 v4, v4, v17
    v_mov_b32 v16, 0x40000000
    v_cndmask_b32 v4, v4, v16, s[82:83]
    v_cvt_pk_bf16_f32 v108, v248, v249
    v_cvt_pk_bf16_f32 v109, v250, v251
    ds_write_b64 v2, v[108:109] offset:1024
    v_mfma_f32_16x16x32_bf16 v[248:251], v[192:195], v[148:151], 0
    v_cndmask_b32 v6, v6, v16, s[82:83]
    s_mul_i32 s72, s77, 3328
    s_add_u32 s72, s72, 1048576
    v_cvt_pk_bf16_f32 v110, v252, v253
    v_cvt_pk_bf16_f32 v111, v254, v255
    ds_write_b64 v2, v[110:111] offset:1536
    v_mfma_f32_16x16x32_bf16 v[252:255], v[196:199], v[148:151], 0
    s_mul_i32 s73, s77, 2560
    v_cvt_pk_bf16_f32 v108, v64, v65
    v_cvt_pk_bf16_f32 v109, v66, v67
    ds_write_b64 v2, v[108:109] offset:2048
    v_mfma_f32_16x16x32_bf16 v[64:67], v[200:203], v[148:151], 0
    ds_read_b64 v[114:115], v17 offset:6400
    v_mfma_f32_16x16x32_bf16 v[128:131], v[204:207], v[152:155], v[128:131]
    v_mfma_f32_16x16x32_bf16 v[132:135], v[208:211], v[152:155], v[132:135]
    v_mfma_f32_16x16x32_bf16 v[248:251], v[212:215], v[152:155], v[248:251]
    s_waitcnt lgkmcnt(1)
    s_barrier
    ds_read_b64_tr_b16 v[144:145], v3 offset:0
    ds_read_b64_tr_b16 v[146:147], v3 offset:10368
    s_add_u32 s69, s72, 0
    buffer_load_dwordx2 v[16:17], v6, s[36:39], s69 offen sc1
    s_add_u32 s69, s72, 6656
    buffer_load_dwordx2 v[18:19], v6, s[36:39], s69 offen sc1
    v_mfma_f32_16x16x32_bf16 v[252:255], v[216:219], v[152:155], v[252:255]
    ds_read_b64_tr_b16 v[136:137], v3 offset:512
    ds_read_b64_tr_b16 v[138:139], v3 offset:10880
    v_mfma_f32_16x16x32_bf16 v[64:67], v[220:223], v[152:155], v[64:67]
    ds_read_b64_tr_b16 v[140:141], v7 offset:1024
    ds_read_b64_tr_b16 v[142:143], v7 offset:11392
    v_mfma_f32_16x16x32_bf16 v[128:131], v[224:227], v[156:159], v[128:131]
    s_add_u32 s71, s79, 7634944
    buffer_load_dwordx4 v[172:175], v1, s[36:39], s71 offen sc1
    v_mfma_f32_16x16x32_bf16 v[132:135], v[228:231], v[156:159], v[132:135]
    s_add_u32 s71, s12, 7635968
    buffer_load_dwordx4 v[176:179], v1, s[36:39], s71 offen sc1
    v_mfma_f32_16x16x32_bf16 v[248:251], v[232:235], v[156:159], v[248:251]
    s_waitcnt lgkmcnt(4)
    v_mfma_f32_16x16x32_bf16 v[104:107], v[144:147], v[92:95], 0
    s_add_u32 s71, s79, 7636992
    buffer_load_dwordx4 v[180:183], v1, s[36:39], s71 offen sc1
    v_mfma_f32_16x16x32_bf16 v[252:255], v[236:239], v[156:159], v[252:255]
    v_lshlrev_b32 v112, 16, v114
    v_and_b32 v113, 0xffff0000, v114
    v_lshlrev_b32 v114, 16, v115
    v_and_b32 v115, 0xffff0000, v115
    s_waitcnt lgkmcnt(2)
    v_mfma_f32_16x16x32_bf16 v[104:107], v[136:139], v[96:99], v[104:107]
    v_mfma_f32_16x16x32_bf16 v[64:67], v[240:243], v[156:159], v[64:67]
    s_waitcnt lgkmcnt(0)
    v_mfma_f32_16x16x32_bf16 v[104:107], v[140:143], v[100:103], v[104:107]
    v_mfma_f32_16x16x32_bf16 v[128:131], v[244:247], v[52:55], v[128:131]
    s_add_u32 s71, s12, 7638016
    buffer_load_dwordx4 v[136:139], v1, s[36:39], s71 offen sc1
    v_mfma_f32_16x16x32_bf16 v[132:135], v[116:119], v[52:55], v[132:135]
    s_add_u32 s71, s79, 7639040
    buffer_load_dwordx4 v[140:143], v1, s[36:39], s71 offen sc1
    v_mfma_f32_16x16x32_bf16 v[248:251], v[120:123], v[52:55], v[248:251]
    v_mfma_f32_16x16x32_bf16 v[252:255], v[124:127], v[52:55], v[252:255]
    v_mfma_f32_16x16x32_bf16 v[64:67], v[160:163], v[52:55], v[64:67]
    v_mfma_f32_16x16x32_bf16 v[128:131], v[164:167], v[56:59], v[128:131]
    v_mfma_f32_16x16x32_bf16 v[132:135], v[168:171], v[56:59], v[132:135]
    s_waitcnt vmcnt(6)
    v_lshlrev_b32 v144, 16, v16
    v_mfma_f32_16x16x32_bf16 v[248:251], v[20:23], v[56:59], v[248:251]
    v_and_b32 v145, 0xffff0000, v16
    v_lshlrev_b32 v146, 16, v17
    v_mfma_f32_16x16x32_bf16 v[252:255], v[24:27], v[56:59], v[252:255]
    v_and_b32 v147, 0xffff0000, v17
    v_fmac_f32 v144, v112, v104
    v_mfma_f32_16x16x32_bf16 v[64:67], v[28:31], v[56:59], v[64:67]
    v_fmac_f32 v145, v113, v105
    v_fmac_f32 v146, v114, v106
    v_mfma_f32_16x16x32_bf16 v[128:131], v[32:35], v[60:63], v[128:131]
    v_fmac_f32 v147, v115, v107
    v_cvt_pk_bf16_f32 v16, v144, v145
    v_mfma_f32_16x16x32_bf16 v[132:135], v[36:39], v[60:63], v[132:135]
    v_cvt_pk_bf16_f32 v17, v146, v147
    s_add_u32 s69, s73, 0
    buffer_store_dwordx2 v[16:17], v4, s[32:35], s69 offen
    v_mfma_f32_16x16x32_bf16 v[248:251], v[40:43], v[60:63], v[248:251]
    s_add_u32 s69, s72, 13312
    buffer_load_dwordx2 v[16:17], v6, s[36:39], s69 offen sc1
    s_add_u32 s71, s12, 7640064
    buffer_load_dwordx4 v[144:147], v1, s[36:39], s71 offen sc1
    v_max3_u32 v13, v68, v72, v76
    v_max3_u32 v12, v80, v84, v88
    v_mfma_f32_16x16x32_bf16 v[252:255], v[44:47], v[60:63], v[252:255]
    v_max_u32 v13, v13, v12
    v_cmp_eq_u32 vcc, -1, v13
    v_mfma_f32_16x16x32_bf16 v[64:67], v[48:51], v[60:63], v[64:67]
    s_cbranch_vccnz L_rt_58
L_ok_57:
    v_cvt_pk_bf16_f32 v108, v128, v129
    v_cvt_pk_bf16_f32 v109, v130, v131
    ds_write_b64 v2, v[108:109] offset:20736
    v_mfma_f32_16x16x32_bf16 v[128:131], v[184:187], v[68:71], 0
    v_cvt_pk_bf16_f32 v110, v132, v133
    v_cvt_pk_bf16_f32 v111, v134, v135
    ds_write_b64 v2, v[110:111] offset:21248
    v_mfma_f32_16x16x32_bf16 v[132:135], v[188:191], v[68:71], 0
    v_cvt_pk_bf16_f32 v108, v248, v249
    v_cvt_pk_bf16_f32 v109, v250, v251
    ds_write_b64 v2, v[108:109] offset:21760
    v_mfma_f32_16x16x32_bf16 v[248:251], v[192:195], v[68:71], 0
    v_cvt_pk_bf16_f32 v110, v252, v253
    v_cvt_pk_bf16_f32 v111, v254, v255
    ds_write_b64 v2, v[110:111] offset:22272
    v_mfma_f32_16x16x32_bf16 v[252:255], v[196:199], v[68:71], 0
    v_cvt_pk_bf16_f32 v108, v64, v65
    v_cvt_pk_bf16_f32 v109, v66, v67
    ds_write_b64 v2, v[108:109] offset:22784
    v_mfma_f32_16x16x32_bf16 v[64:67], v[200:203], v[68:71], 0
    v_mfma_f32_16x16x32_bf16 v[128:131], v[204:207], v[72:75], v[128:131]
    v_mfma_f32_16x16x32_bf16 v[132:135], v[208:211], v[72:75], v[132:135]
    v_mfma_f32_16x16x32_bf16 v[248:251], v[212:215], v[72:75], v[248:251]
    s_waitcnt lgkmcnt(0)
    s_barrier
    ds_read_b64_tr_b16 v[60:61], v3 offset:20736
    ds_read_b64_tr_b16 v[62:63], v3 offset:31104
    v_mfma_f32_16x16x32_bf16 v[252:255], v[216:219], v[72:75], v[252:255]
    ds_read_b64_tr_b16 v[52:53], v3 offset:21248
    ds_read_b64_tr_b16 v[54:55], v3 offset:31616
    v_mfma_f32_16x16x32_bf16 v[64:67], v[220:223], v[72:75], v[64:67]
    ds_read_b64_tr_b16 v[56:57], v7 offset:21760
    ds_read_b64_tr_b16 v[58:59], v7 offset:32128
    v_mfma_f32_16x16x32_bf16 v[128:131], v[224:227], v[76:79], v[128:131]
    v_mfma_f32_16x16x32_bf16 v[132:135], v[228:231], v[76:79], v[132:135]
    v_mfma_f32_16x16x32_bf16 v[248:251], v[232:235], v[76:79], v[248:251]
    s_waitcnt lgkmcnt(4)
    v_mfma_f32_16x16x32_bf16 v[104:107], v[60:63], v[92:95], 0
    v_mfma_f32_16x16x32_bf16 v[252:255], v[236:239], v[76:79], v[252:255]
    s_waitcnt lgkmcnt(2)
    v_mfma_f32_16x16x32_bf16 v[104:107], v[52:55], v[96:99], v[104:107]
    v_mfma_f32_16x16x32_bf16 v[64:67], v[240:243], v[76:79], v[64:67]
    s_waitcnt lgkmcnt(0)
    v_mfma_f32_16x16x32_bf16 v[104:107], v[56:59], v[100:103], v[104:107]
    v_mfma_f32_16x16x32_bf16 v[128:131], v[244:247], v[80:83], v[128:131]
    v_mfma_f32_16x16x32_bf16 v[132:135], v[116:119], v[80:83], v[132:135]
    v_mfma_f32_16x16x32_bf16 v[248:251], v[120:123], v[80:83], v[248:251]
    v_mfma_f32_16x16x32_bf16 v[252:255], v[124:127], v[80:83], v[252:255]
    v_mfma_f32_16x16x32_bf16 v[64:67], v[160:163], v[80:83], v[64:67]
    v_mfma_f32_16x16x32_bf16 v[128:131], v[164:167], v[84:87], v[128:131]
    v_mfma_f32_16x16x32_bf16 v[132:135], v[168:171], v[84:87], v[132:135]
    s_waitcnt vmcnt(8)
    v_lshlrev_b32 v60, 16, v18
    v_mfma_f32_16x16x32_bf16 v[248:251], v[20:23], v[84:87], v[248:251]
    v_and_b32 v61, 0xffff0000, v18
    v_lshlrev_b32 v62, 16, v19
    v_mfma_f32_16x16x32_bf16 v[252:255], v[24:27], v[84:87], v[252:255]
    v_and_b32 v63, 0xffff0000, v19
    v_fmac_f32 v60, v112, v104
    v_mfma_f32_16x16x32_bf16 v[64:67], v[28:31], v[84:87], v[64:67]
    v_fmac_f32 v61, v113, v105
    v_fmac_f32 v62, v114, v106
    v_mfma_f32_16x16x32_bf16 v[128:131], v[32:35], v[88:91], v[128:131]
    v_fmac_f32 v63, v115, v107
    v_cvt_pk_bf16_f32 v18, v60, v61
    v_mfma_f32_16x16x32_bf16 v[132:135], v[36:39], v[88:91], v[132:135]
    v_cvt_pk_bf16_f32 v19, v62, v63
    s_add_u32 s69, s73, 5120
    buffer_store_dwordx2 v[18:19], v4, s[32:35], s69 offen
    v_mfma_f32_16x16x32_bf16 v[248:251], v[40:43], v[88:91], v[248:251]
    s_add_u32 s69, s72, 19968
    buffer_load_dwordx2 v[18:19], v6, s[36:39], s69 offen sc1
    s_waitcnt vmcnt(2)
    v_max3_u32 v13, v172, v176, v180
    v_max3_u32 v12, v136, v140, v144
    v_mfma_f32_16x16x32_bf16 v[252:255], v[44:47], v[88:91], v[252:255]
    v_max_u32 v13, v13, v12
    v_cmp_eq_u32 vcc, -1, v13
    v_mfma_f32_16x16x32_bf16 v[64:67], v[48:51], v[88:91], v[64:67]
    s_cbranch_vccnz L_rt_60
L_ok_59:
    v_cvt_pk_bf16_f32 v108, v128, v129
    v_cvt_pk_bf16_f32 v109, v130, v131
    ds_write_b64 v2, v[108:109] offset:0
    v_mfma_f32_16x16x32_bf16 v[128:131], v[184:187], v[172:175], 0
    v_cvt_pk_bf16_f32 v110, v132, v133
    v_cvt_pk_bf16_f32 v111, v134, v135
    ds_write_b64 v2, v[110:111] offset:512
    v_mfma_f32_16x16x32_bf16 v[132:135], v[188:191], v[172:175], 0
    v_cvt_pk_bf16_f32 v108, v248, v249
    v_cvt_pk_bf16_f32 v109, v250, v251
    ds_write_b64 v2, v[108:109] offset:1024
    v_mfma_f32_16x16x32_bf16 v[248:251], v[192:195], v[172:175], 0
    v_cvt_pk_bf16_f32 v110, v252, v253
    v_cvt_pk_bf16_f32 v111, v254, v255
    ds_write_b64 v2, v[110:111] offset:1536
    v_mfma_f32_16x16x32_bf16 v[252:255], v[196:199], v[172:175], 0
    v_cvt_pk_bf16_f32 v108, v64, v65
    v_cvt_pk_bf16_f32 v109, v66, v67
    ds_write_b64 v2, v[108:109] offset:2048
    v_mfma_f32_16x16x32_bf16 v[64:67], v[200:203], v[172:175], 0
    v_mfma_f32_16x16x32_bf16 v[128:131], v[204:207], v[176:179], v[128:131]
    v_mfma_f32_16x16x32_bf16 v[132:135], v[208:211], v[176:179], v[132:135]
    v_mfma_f32_16x16x32_bf16 v[248:251], v[212:215], v[176:179], v[248:251]
    s_waitcnt lgkmcnt(0)
    s_barrier
    ds_read_b64_tr_b16 v[88:89], v3 offset:0
    ds_read_b64_tr_b16 v[90:91], v3 offset:10368
    v_mfma_f32_16x16x32_bf16 v[252:255], v[216:219], v[176:179], v[252:255]
    ds_read_b64_tr_b16 v[80:81], v3 offset:512
    ds_read_b64_tr_b16 v[82:83], v3 offset:10880
    v_mfma_f32_16x16x32_bf16 v[64:67], v[220:223], v[176:179], v[64:67]
    ds_read_b64_tr_b16 v[84:85], v7 offset:1024
    ds_read_b64_tr_b16 v[86:87], v7 offset:11392
    v_mfma_f32_16x16x32_bf16 v[128:131], v[224:227], v[180:183], v[128:131]
    v_mfma_f32_16x16x32_bf16 v[132:135], v[228:231], v[180:183], v[132:135]
    v_mfma_f32_16x16x32_bf16 v[248:251], v[232:235], v[180:183], v[248:251]
    s_waitcnt lgkmcnt(4)
    v_mfma_f32_16x16x32_bf16 v[104:107], v[88:91], v[92:95], 0
    v_mfma_f32_16x16x32_bf16 v[252:255], v[236:239], v[180:183], v[252:255]
    s_waitcnt lgkmcnt(2)
    v_mfma_f32_16x16x32_bf16 v[104:107], v[80:83], v[96:99], v[104:107]
    v_mfma_f32_16x16x32_bf16 v[64:67], v[240:243], v[180:183], v[64:67]
    s_waitcnt lgkmcnt(0)
    v_mfma_f32_16x16x32_bf16 v[104:107], v[84:87], v[100:103], v[104:107]
    v_mfma_f32_16x16x32_bf16 v[128:131], v[244:247], v[136:139], v[128:131]
    v_mfma_f32_16x16x32_bf16 v[132:135], v[116:119], v[136:139], v[132:135]
    v_mfma_f32_16x16x32_bf16 v[248:251], v[120:123], v[136:139], v[248:251]
    v_mfma_f32_16x16x32_bf16 v[252:255], v[124:127], v[136:139], v[252:255]
    v_mfma_f32_16x16x32_bf16 v[64:67], v[160:163], v[136:139], v[64:67]
    v_mfma_f32_16x16x32_bf16 v[128:131], v[164:167], v[140:143], v[128:131]
    v_mfma_f32_16x16x32_bf16 v[132:135], v[168:171], v[140:143], v[132:135]
    v_lshlrev_b32 v88, 16, v16
    v_mfma_f32_16x16x32_bf16 v[248:251], v[20:23], v[140:143], v[248:251]
    v_and_b32 v89, 0xffff0000, v16
    v_lshlrev_b32 v90, 16, v17
    v_mfma_f32_16x16x32_bf16 v[252:255], v[24:27], v[140:143], v[252:255]
    v_and_b32 v91, 0xffff0000, v17
    v_fmac_f32 v88, v112, v104
    v_mfma_f32_16x16x32_bf16 v[64:67], v[28:31], v[140:143], v[64:67]
    v_fmac_f32 v89, v113, v105
    v_fmac_f32 v90, v114, v106
    v_mfma_f32_16x16x32_bf16 v[128:131], v[32:35], v[144:147], v[128:131]
    v_fmac_f32 v91, v115, v107
    v_cvt_pk_bf16_f32 v16, v88, v89
    v_mfma_f32_16x16x32_bf16 v[132:135], v[36:39], v[144:147], v[132:135]
    v_cvt_pk_bf16_f32 v17, v90, v91
    s_add_u32 s69, s73, 10240
    buffer_store_dwordx2 v[16:17], v4, s[32:35], s69 offen
    v_mfma_f32_16x16x32_bf16 v[248:251], v[40:43], v[144:147], v[248:251]
    v_mfma_f32_16x16x32_bf16 v[252:255], v[44:47], v[144:147], v[252:255]
    v_mfma_f32_16x16x32_bf16 v[64:67], v[48:51], v[144:147], v[64:67]
    v_cvt_pk_bf16_f32 v108, v128, v129
    v_cvt_pk_bf16_f32 v109, v130, v131
    ds_write_b64 v2, v[108:109] offset:20736
    v_cvt_pk_bf16_f32 v110, v132, v133
    v_cvt_pk_bf16_f32 v111, v134, v135
    ds_write_b64 v2, v[110:111] offset:21248
    v_cvt_pk_bf16_f32 v108, v248, v249
    v_cvt_pk_bf16_f32 v109, v250, v251
    ds_write_b64 v2, v[108:109] offset:21760
    v_cvt_pk_bf16_f32 v110, v252, v253
    v_cvt_pk_bf16_f32 v111, v254, v255
    ds_write_b64 v2, v[110:111] offset:22272
    v_cvt_pk_bf16_f32 v108, v64, v65
    v_cvt_pk_bf16_f32 v109, v66, v67
    ds_write_b64 v2, v[108:109] offset:22784
    s_waitcnt lgkmcnt(0)
    s_barrier
    ds_read_b64_tr_b16 v[144:145], v3 offset:20736
    ds_read_b64_tr_b16 v[146:147], v3 offset:31104
    ds_read_b64_tr_b16 v[136:137], v3 offset:21248
    ds_read_b64_tr_b16 v[138:139], v3 offset:31616
    ds_read_b64_tr_b16 v[140:141], v7 offset:21760
    ds_read_b64_tr_b16 v[142:143], v7 offset:32128
    s_waitcnt vmcnt(1)
    v_lshlrev_b32 v172, 16, v18
    v_and_b32 v173, 0xffff0000, v18
    v_lshlrev_b32 v174, 16, v19
    v_and_b32 v175, 0xffff0000, v19
    s_waitcnt lgkmcnt(4)
    v_mfma_f32_16x16x32_bf16 v[104:107], v[144:147], v[92:95], 0
    s_waitcnt lgkmcnt(2)
    v_mfma_f32_16x16x32_bf16 v[104:107], v[136:139], v[96:99], v[104:107]
    s_waitcnt lgkmcnt(0)
    v_mfma_f32_16x16x32_bf16 v[104:107], v[140:143], v[100:103], v[104:107]
    s_nop 7
    v_fmac_f32 v172, v112, v104
    v_fmac_f32 v173, v113, v105
    v_fmac_f32 v174, v114, v106
    v_fmac_f32 v175, v115, v107
    v_cvt_pk_bf16_f32 v18, v172, v173
    v_cvt_pk_bf16_f32 v19, v174, v175
    s_add_u32 s69, s73, 15360
    buffer_store_dwordx2 v[18:19], v4, s[32:35], s69 offen
L_end:
    s_endpgm
L_rt_9:
    s_add_u32 s43, s43, 1
    s_cmp_gt_u32 s43, 3000000
    s_nop 0
    s_cbranch_scc1 L_end
    s_sleep 4
    buffer_load_dwordx4 v[136:139], v20, s[36:39], s70 offen offset:0 sc1
    buffer_load_dwordx4 v[140:143], v20, s[36:39], s70 offen offset:256 sc1
    buffer_load_dwordx4 v[144:147], v20, s[36:39], s70 offen offset:512 sc1
    buffer_load_dwordx4 v[148:151], v20, s[36:39], s70 offen offset:768 sc1
    buffer_load_dwordx4 v[152:155], v20, s[36:39], s70 offen offset:1024 sc1
    s_cmp_lt_u32 s72, 80
    s_cbranch_scc0 L_sk_61
    buffer_load_dwordx4 v[156:159], v20, s[36:39], s74 offen sc1
L_sk_61:
    s_waitcnt vmcnt(0)
    v_xor_b32 v45, s40, v137
    v_bitop3_b32 v45, v45, v139, s40 bitop3:0xf6
    v_bitop3_b32 v45, v45, v141, s40 bitop3:0xf6
    v_bitop3_b32 v45, v45, v143, s40 bitop3:0xf6
    v_bitop3_b32 v45, v45, v145, s40 bitop3:0xf6
    v_bitop3_b32 v45, v45, v147, s40 bitop3:0xf6
    v_bitop3_b32 v45, v45, v149, s40 bitop3:0xf6
    v_bitop3_b32 v45, v45, v151, s40 bitop3:0xf6
    v_bitop3_b32 v45, v45, v153, s40 bitop3:0xf6
    v_bitop3_b32 v45, v45, v155, s40 bitop3:0xf6
    v_bitop3_b32 v45, v45, v157, s40 bitop3:0xf6
    v_bitop3_b32 v45, v45, v159, s40 bitop3:0xf6
    v_cmp_ne_u32 vcc, 0, v45
    s_nop 3
    s_cbranch_vccnz L_rt_9
    s_branch L_ok_10
L_rt_14:
    s_add_u32 s43, s43, 1
    s_cmp_gt_u32 s43, 3000000
    s_cbranch_scc1 L_end
    s_sleep 1
    v_cmp_ne_u32 vcc, s40, v24
    s_nop 0
    s_and_b64 vcc, vcc, s[64:65]
    s_cbranch_scc0 L_sk_62
    buffer_load_dword v24, v8, s[36:39], s72 offen offset:0 sc1
L_sk_62:
    v_cmp_ne_u32 vcc, s40, v25
    s_nop 0
    s_and_b64 vcc, vcc, s[64:65]
    s_cbranch_scc0 L_sk_63
    buffer_load_dword v25, v8, s[36:39], s73 offen offset:0 sc1
L_sk_63:
    v_cmp_ne_u32 vcc, s40, v26
    s_nop 0
    s_and_b64 vcc, vcc, s[64:65]
    s_cbranch_scc0 L_sk_64
    buffer_load_dword v26, v8, s[36:39], s74 offen offset:0 sc1
L_sk_64:
    v_cmp_ne_u32 vcc, s40, v27
    s_nop 0
    s_and_b64 vcc, vcc, s[64:65]
    s_cbranch_scc0 L_sk_65
    buffer_load_dword v27, v8, s[36:39], s75 offen offset:0 sc1
L_sk_65:
    v_cmp_ne_u32 vcc, s40, v28
    s_nop 0
    s_and_b64 vcc, vcc, s[64:65]
    s_cbranch_scc0 L_sk_66
    buffer_load_dword v28, v8, s[36:39], s72 offen offset:1664 sc1
L_sk_66:
    v_cmp_ne_u32 vcc, s40, v29
    s_nop 0
    s_and_b64 vcc, vcc, s[64:65]
    s_cbranch_scc0 L_sk_67
    buffer_load_dword v29, v8, s[36:39], s73 offen offset:1664 sc1
L_sk_67:
    v_cmp_ne_u32 vcc, s40, v30
    s_nop 0
    s_and_b64 vcc, vcc, s[64:65]
    s_cbranch_scc0 L_sk_68
    buffer_load_dword v30, v8, s[36:39], s74 offen offset:1664 sc1
L_sk_68:
    v_cmp_ne_u32 vcc, s40, v31
    s_nop 0
    s_and_b64 vcc, vcc, s[64:65]
    s_cbranch_scc0 L_sk_69
    buffer_load_dword v31, v8, s[36:39], s75 offen offset:1664 sc1
L_sk_69:
    s_waitcnt vmcnt(0)
    v_xor_b32 v44, s40, v24
    v_bitop3_b32 v44, v44, v25, s40 bitop3:0xf6
    v_bitop3_b32 v44, v44, v26, s40 bitop3:0xf6
    v_bitop3_b32 v44, v44, v27, s40 bitop3:0xf6
    v_bitop3_b32 v44, v44, v28, s40 bitop3:0xf6
    v_bitop3_b32 v44, v44, v29, s40 bitop3:0xf6
    v_bitop3_b32 v44, v44, v30, s40 bitop3:0xf6
    v_bitop3_b32 v44, v44, v31, s40 bitop3:0xf6
    v_cmp_ne_u32 vcc, 0, v44
    s_nop 0
    s_and_b64 vcc, vcc, s[64:65]
    s_nop 1
    s_cbranch_scc1 L_rt_14
    s_branch L_ok_15
L_rt_17:
    s_add_u32 s43, s43, 1
    s_cmp_gt_u32 s43, 3000000
    s_nop 0
    s_cbranch_scc1 L_end
    s_sleep 4
    buffer_load_dwordx4 v[248:251], v20, s[36:39], s70 offen sc1
    buffer_load_dwordx4 v[252:255], v21, s[36:39], s71 offen sc1
    s_waitcnt vmcnt(0)
    v_xor_b32 v83, s40, v249
    v_bitop3_b32 v83, v83, v251, s40 bitop3:0xf6
    v_bitop3_b32 v83, v83, v253, s40 bitop3:0xf6
    v_bitop3_b32 v83, v83, v255, s40 bitop3:0xf6
    v_cmp_ne_u32 vcc, 0, v83
    s_nop 3
    s_cbranch_vccnz L_rt_17
    s_branch L_ok_18
L_rt_20:
    s_add_u32 s43, s43, 1
    s_cmp_gt_u32 s43, 3000000
    s_nop 0
    s_cbranch_scc1 L_end
    s_sleep 4
    buffer_load_dwordx4 v[248:251], v20, s[36:39], s70 offen sc1
    buffer_load_dwordx4 v[252:255], v21, s[36:39], s71 offen sc1
    s_waitcnt vmcnt(0)
    v_xor_b32 v83, s40, v249
    v_bitop3_b32 v83, v83, v251, s40 bitop3:0xf6
    v_bitop3_b32 v83, v83, v253, s40 bitop3:0xf6
    v_bitop3_b32 v83, v83, v255, s40 bitop3:0xf6
    v_cmp_ne_u32 vcc, 0, v83
    s_nop 3
    s_cbranch_vccnz L_rt_20
    s_branch L_ok_21
L_rt_24:
    s_add_u32 s43, s43, 1
    s_cmp_gt_u32 s43, 3000000
    s_nop 0
    s_cbranch_scc1 L_end
    s_sleep 4
    buffer_load_dword v32, v33, s[36:39], s80 offen sc1
    s_waitcnt vmcnt(0)
    v_cmp_ne_u32 vcc, s40, v32
    s_nop 3
    s_cbranch_vccnz L_rt_24
    s_branch L_ok_25
L_rt_26:
    s_add_u32 s43, s43, 1
    s_cmp_gt_u32 s43, 3000000
    s_cbranch_scc1 L_end
    s_sleep 1
    v_cmp_ne_u32 vcc, s45, v24
    s_nop 0
    s_and_b64 vcc, vcc, s[64:65]
    s_cbranch_scc0 L_sk_70
    buffer_load_dword v24, v6, s[36:39], s44 offen offset:0 sc1
L_sk_70:
    v_cmp_ne_u32 vcc, s45, v25
    s_nop 0
    s_and_b64 vcc, vcc, s[64:65]
    s_cbranch_scc0 L_sk_71
    buffer_load_dword v25, v7, s[36:39], s44 offen offset:0 sc1
L_sk_71:
    v_cmp_ne_u32 vcc, s45, v26
    s_nop 0
    s_and_b64 vcc, vcc, s[64:65]
    s_cbranch_scc0 L_sk_72
    buffer_load_dword v26, v6, s[36:39], s44 offen offset:512 sc1
L_sk_72:
    v_cmp_ne_u32 vcc, s45, v27
    s_nop 0
    s_and_b64 vcc, vcc, s[64:65]
    s_cbranch_scc0 L_sk_73
    buffer_load_dword v27, v7, s[36:39], s44 offen offset:512 sc1
L_sk_73:
    v_cmp_ne_u32 vcc, s45, v28
    s_nop 0
    s_and_b64 vcc, vcc, s[64:65]
    s_cbranch_scc0 L_sk_74
    buffer_load_dword v28, v6, s[36:39], s59 offen offset:512 sc1
L_sk_74:
    v_cmp_ne_u32 vcc, s45, v29
    s_nop 0
    s_and_b64 vcc, vcc, s[64:65]
    s_cbranch_scc0 L_sk_75
    buffer_load_dword v29, v7, s[36:39], s59 offen offset:512 sc1
L_sk_75:
    s_waitcnt vmcnt(0)
    v_xor_b32 v44, s45, v24
    v_bitop3_b32 v44, v44, v25, s45 bitop3:0xf6
    v_bitop3_b32 v44, v44, v26, s45 bitop3:0xf6
    v_bitop3_b32 v44, v44, v27, s45 bitop3:0xf6
    v_bitop3_b32 v44, v44, v28, s45 bitop3:0xf6
    v_bitop3_b32 v44, v44, v29, s45 bitop3:0xf6
    v_cmp_ne_u32 vcc, 0, v44
    s_nop 0
    s_and_b64 vcc, vcc, s[64:65]
    s_nop 1
    s_cbranch_scc1 L_rt_26
    s_branch L_ok_27
L_rt_28:
    s_add_u32 s43, s43, 1
    s_cmp_gt_u32 s43, 3000000
    s_nop 0
    s_cbranch_scc1 L_end
    s_sleep 4
    s_mov_b32 exec_hi, 0
    buffer_load_dword v87, v17, s[36:39], s76 offen sc1
    s_mov_b32 exec_hi, -1
    s_waitcnt vmcnt(0)
    v_cmp_ne_u32 vcc, s40, v87
    s_nop 3
    s_cbranch_vccnz L_rt_28
    s_branch L_ok_29
L_rt_34:
    s_add_u32 s43, s43, 1
    s_cmp_gt_u32 s43, 3000000
    s_nop 0
    s_cbranch_scc1 L_ok_33
    s_sleep 4
    s_mov_b32 s80, m0
    s_add_u32 m0, s78, 0
    s_nop 0
    buffer_load_dwordx4 v1, s[36:39], s84 offen offset:0 sc1 lds
    buffer_load_dwordx4 v1, s[36:39], s84 offen offset:1024 sc1 lds
    s_waitcnt vmcnt(0)
    ds_read_b32 v18, v16 offset:0
    s_mov_b32 m0, s80
    s_waitcnt lgkmcnt(0)
    v_cmp_eq_u32 vcc, -1, v18
    s_nop 3
    s_cbranch_vccnz L_rt_34
    s_branch L_ok_33
L_rt_36:
    s_add_u32 s43, s43, 1
    s_cmp_gt_u32 s43, 3000000
    s_nop 3
    s_cbranch_scc1 L_ok_35
    s_sleep 4
    s_mov_b32 s80, m0
    s_add_u32 m0, s78, 16384
    s_nop 0
    buffer_load_dwordx4 v1, s[36:39], s85 offen offset:0 sc1 lds
    buffer_load_dwordx4 v1, s[36:39], s85 offen offset:1024 sc1 lds
    s_waitcnt vmcnt(0)
    ds_read_b32 v18, v16 offset:16384
    s_mov_b32 m0, s80
    s_waitcnt lgkmcnt(0)
    v_cmp_eq_u32 vcc, -1, v18
    s_nop 3
    s_cbranch_vccnz L_rt_36
    s_branch L_ok_35
L_rt_38:
    s_add_u32 s43, s43, 1
    s_cmp_gt_u32 s43, 3000000
    s_nop 3
    s_cbranch_scc1 L_ok_37
    s_sleep 4
    s_mov_b32 s80, m0
    s_add_u32 m0, s78, 32768
    s_nop 0
    buffer_load_dwordx4 v1, s[36:39], s86 offen offset:0 sc1 lds
    buffer_load_dwordx4 v1, s[36:39], s86 offen offset:1024 sc1 lds
    s_waitcnt vmcnt(0)
    ds_read_b32 v18, v16 offset:32768
    s_mov_b32 m0, s80
    s_waitcnt lgkmcnt(0)
    v_cmp_eq_u32 vcc, -1, v18
    s_nop 3
    s_cbranch_vccnz L_rt_38
    s_branch L_ok_37
L_rt_40:
    s_add_u32 s43, s43, 1
    s_cmp_gt_u32 s43, 3000000
    s_nop 3
    s_cbranch_scc1 L_ok_39
    s_sleep 4
    s_mov_b32 s80, m0
    s_add_u32 m0, s78, 49152
    s_nop 0
    buffer_load_dwordx4 v1, s[36:39], s87 offen offset:0 sc1 lds
    buffer_load_dwordx4 v1, s[36:39], s87 offen offset:1024 sc1 lds
    s_waitcnt vmcnt(0)
    ds_read_b32 v18, v16 offset:49152
    s_mov_b32 m0, s80
    s_waitcnt lgkmcnt(0)
    v_cmp_eq_u32 vcc, -1, v18
    s_nop 3
    s_cbranch_vccnz L_rt_40
    s_branch L_ok_39
L_rt_42:
    s_add_u32 s43, s43, 1
    s_cmp_gt_u32 s43, 3000000
    s_nop 3
    s_cbranch_scc1 L_ok_41
    s_sleep 4
    s_mov_b32 s80, m0
    s_add_u32 m0, s78, 65536
    s_nop 0
    buffer_load_dwordx4 v1, s[36:39], s88 offen offset:0 sc1 lds
    buffer_load_dwordx4 v1, s[36:39], s88 offen offset:1024 sc1 lds
    s_waitcnt vmcnt(0)
    ds_read_b32 v18, v17 offset:0
    s_mov_b32 m0, s80
    s_waitcnt lgkmcnt(0)
    v_cmp_eq_u32 vcc, -1, v18
    s_nop 3
    s_cbranch_vccnz L_rt_42
    s_branch L_ok_41
L_rt_44:
    s_add_u32 s43, s43, 1
    s_cmp_gt_u32 s43, 3000000
    s_nop 2
    s_cbranch_scc1 L_ok_43
    s_sleep 4
    s_mov_b32 s80, m0
    s_add_u32 m0, s78, 81920
    s_nop 0
    buffer_load_dwordx4 v1, s[36:39], s89 offen offset:0 sc1 lds
    buffer_load_dwordx4 v1, s[36:39], s89 offen offset:1024 sc1 lds
    s_waitcnt vmcnt(0)
    ds_read_b32 v18, v17 offset:16384
    s_mov_b32 m0, s80
    s_waitcnt lgkmcnt(0)
    v_cmp_eq_u32 vcc, -1, v18
    s_nop 3
    s_cbranch_vccnz L_rt_44
    s_branch L_ok_43
L_rt_46:
    s_add_u32 s43, s43, 1
    s_cmp_gt_u32 s43, 3000000
    s_nop 3
    s_cbranch_scc1 L_ok_45
    s_sleep 4
    s_mov_b32 s80, m0
    s_add_u32 m0, s78, 98304
    s_nop 0
    buffer_load_dwordx4 v1, s[36:39], s90 offen offset:0 sc1 lds
    buffer_load_dwordx4 v1, s[36:39], s90 offen offset:1024 sc1 lds
    s_waitcnt vmcnt(0)
    ds_read_b32 v18, v17 offset:32768
    s_mov_b32 m0, s80
    s_waitcnt lgkmcnt(0)
    v_cmp_eq_u32 vcc, -1, v18
    s_nop 3
    s_cbranch_vccnz L_rt_46
    s_branch L_ok_45
L_rt_48:
    s_add_u32 s43, s43, 1
    s_cmp_gt_u32 s43, 3000000
    s_nop 2
    s_cbranch_scc1 L_ok_47
    s_sleep 4
    s_mov_b32 s80, m0
    s_add_u32 m0, s78, 114688
    s_nop 0
    buffer_load_dwordx4 v1, s[36:39], s91 offen offset:0 sc1 lds
    buffer_load_dwordx4 v1, s[36:39], s91 offen offset:1024 sc1 lds
    s_waitcnt vmcnt(0)
    ds_read_b32 v18, v17 offset:49152
    s_mov_b32 m0, s80
    s_waitcnt lgkmcnt(0)
    v_cmp_eq_u32 vcc, -1, v18
    s_nop 3
    s_cbranch_vccnz L_rt_48
    s_branch L_ok_47
L_rt_50:
    s_add_u32 s43, s43, 1
    s_cmp_gt_u32 s43, 3000000
    s_nop 3
    s_cbranch_scc1 L_ok_49
    s_sleep 4
    s_mov_b32 s80, m0
    s_add_u32 m0, s78, 0
    s_nop 0
    buffer_load_dwordx4 v1, s[36:39], s92 offen offset:0 sc1 lds
    buffer_load_dwordx4 v1, s[36:39], s92 offen offset:1024 sc1 lds
    s_waitcnt vmcnt(0)
    ds_read_b32 v18, v16 offset:0
    s_mov_b32 m0, s80
    s_waitcnt lgkmcnt(0)
    v_cmp_eq_u32 vcc, -1, v18
    s_nop 3
    s_cbranch_vccnz L_rt_50
    s_branch L_ok_49
L_rt_52:
    s_add_u32 s43, s43, 1
    s_cmp_gt_u32 s43, 3000000
    s_nop 3
    s_cbranch_scc1 L_ok_51
    s_sleep 4
    s_mov_b32 s80, m0
    s_add_u32 m0, s78, 16384
    s_nop 0
    buffer_load_dwordx4 v1, s[36:39], s93 offen offset:0 sc1 lds
    buffer_load_dwordx4 v1, s[36:39], s93 offen offset:1024 sc1 lds
    s_waitcnt vmcnt(0)
    ds_read_b32 v18, v16 offset:16384
    s_mov_b32 m0, s80
    s_waitcnt lgkmcnt(0)
    v_cmp_eq_u32 vcc, -1, v18
    s_nop 3
    s_cbranch_vccnz L_rt_52
    s_branch L_ok_51
L_rt_54:
    s_add_u32 s43, s43, 1
    s_cmp_gt_u32 s43, 3000000
    s_nop 0
    s_cbranch_scc1 L_ok_53
    s_sleep 4
    s_mov_b32 s80, s71
    s_add_u32 s71, s79, 7340032
    buffer_load_dwordx4 v[172:175], v1, s[36:39], s71 offen sc1
    s_add_u32 s71, s12, 7341056
    buffer_load_dwordx4 v[176:179], v1, s[36:39], s71 offen sc1
    s_add_u32 s71, s79, 7342080
    buffer_load_dwordx4 v[180:183], v1, s[36:39], s71 offen sc1
    s_add_u32 s71, s12, 7343104
    buffer_load_dwordx4 v[136:139], v1, s[36:39], s71 offen sc1
    s_add_u32 s71, s79, 7344128
    buffer_load_dwordx4 v[140:143], v1, s[36:39], s71 offen sc1
    s_add_u32 s71, s12, 7345152
    buffer_load_dwordx4 v[144:147], v1, s[36:39], s71 offen sc1
    s_mov_b32 s71, s80
    s_waitcnt vmcnt(0)
    v_max3_u32 v13, v172, v176, v180
    v_max3_u32 v12, v136, v140, v144
    v_max_u32 v13, v13, v12
    v_cmp_eq_u32 vcc, -1, v13
    s_nop 3
    s_cbranch_vccnz L_rt_54
    s_branch L_ok_53
L_rt_56:
    s_add_u32 s43, s43, 1
    s_cmp_gt_u32 s43, 3000000
    s_nop 0
    s_cbranch_scc1 L_ok_55
    s_sleep 4
    s_mov_b32 s80, s71
    s_add_u32 s71, s79, 7438336
    buffer_load_dwordx4 v[148:151], v1, s[36:39], s71 offen sc1
    s_add_u32 s71, s12, 7439360
    buffer_load_dwordx4 v[152:155], v1, s[36:39], s71 offen sc1
    s_add_u32 s71, s79, 7440384
    buffer_load_dwordx4 v[156:159], v1, s[36:39], s71 offen sc1
    s_add_u32 s71, s12, 7441408
    buffer_load_dwordx4 v[52:55], v1, s[36:39], s71 offen sc1
    s_add_u32 s71, s79, 7442432
    buffer_load_dwordx4 v[56:59], v1, s[36:39], s71 offen sc1
    s_add_u32 s71, s12, 7443456
    buffer_load_dwordx4 v[60:63], v1, s[36:39], s71 offen sc1
    s_mov_b32 s71, s80
    s_waitcnt vmcnt(0)
    v_max3_u32 v13, v148, v152, v156
    v_max3_u32 v12, v52, v56, v60
    v_max_u32 v13, v13, v12
    v_cmp_eq_u32 vcc, -1, v13
    s_nop 3
    s_cbranch_vccnz L_rt_56
    s_branch L_ok_55
L_rt_58:
    s_add_u32 s43, s43, 1
    s_cmp_gt_u32 s43, 3000000
    s_nop 3
    s_cbranch_scc1 L_ok_57
    s_sleep 4
    s_mov_b32 s80, s71
    s_add_u32 s71, s79, 7536640
    buffer_load_dwordx4 v[68:71], v1, s[36:39], s71 offen sc1
    s_add_u32 s71, s12, 7537664
    buffer_load_dwordx4 v[72:75], v1, s[36:39], s71 offen sc1
    s_add_u32 s71, s79, 7538688
    buffer_load_dwordx4 v[76:79], v1, s[36:39], s71 offen sc1
    s_add_u32 s71, s12, 7539712
    buffer_load_dwordx4 v[80:83], v1, s[36:39], s71 offen sc1
    s_add_u32 s71, s79, 7540736
    buffer_load_dwordx4 v[84:87], v1, s[36:39], s71 offen sc1
    s_add_u32 s71, s12, 7541760
    buffer_load_dwordx4 v[88:91], v1, s[36:39], s71 offen sc1
    s_mov_b32 s71, s80
    s_waitcnt vmcnt(0)
    v_max3_u32 v13, v68, v72, v76
    v_max3_u32 v12, v80, v84, v88
    v_max_u32 v13, v13, v12
    v_cmp_eq_u32 vcc, -1, v13
    s_nop 3
    s_cbranch_vccnz L_rt_58
    s_branch L_ok_57
L_rt_60:
    s_add_u32 s43, s43, 1
    s_cmp_gt_u32 s43, 3000000
    s_nop 3
    s_cbranch_scc1 L_ok_59
    s_sleep 4
    s_mov_b32 s80, s71
    s_add_u32 s71, s79, 7634944
    buffer_load_dwordx4 v[172:175], v1, s[36:39], s71 offen sc1
    s_add_u32 s71, s12, 7635968
    buffer_load_dwordx4 v[176:179], v1, s[36:39], s71 offen sc1
    s_add_u32 s71, s79, 7636992
    buffer_load_dwordx4 v[180:183], v1, s[36:39], s71 offen sc1
    s_add_u32 s71, s12, 7638016
    buffer_load_dwordx4 v[136:139], v1, s[36:39], s71 offen sc1
    s_add_u32 s71, s79, 7639040
    buffer_load_dwordx4 v[140:143], v1, s[36:39], s71 offen sc1
    s_add_u32 s71, s12, 7640064
    buffer_load_dwordx4 v[144:147], v1, s[36:39], s71 offen sc1
    s_mov_b32 s71, s80
    s_waitcnt vmcnt(0)
    v_max3_u32 v13, v172, v176, v180
    v_max3_u32 v12, v136, v140, v144
    v_max_u32 v13, v13, v12
    v_cmp_eq_u32 vcc, -1, v13
    s_nop 3
    s_cbranch_vccnz L_rt_60
    s_branch L_ok_59
L_codeend:
    s_endpgm
.p2align 10
.type tab_data,@object
tab_data:
.quad 0x3f803f803f803f80,0x3f80,0x3f163f4f3f733f80,0x3e9e,0xbe9e3e9e3f4f3f80,0xbf4f,0xbf73be9e3f163f80,0xbf4f
.quad 0xbf4fbf4f3e9e3f80,0x3e9e,0xbf8000003f80,0x3f80,0x3f4fbf4fbe9e3f80,0x3e9e,0x3f73be9ebf163f80,0xbf4f
.quad 0x3e9e3e9ebf4f3f80,0xbf4f,0xbf163f4fbf733f80,0x3e9e,0xbf803f80bf803f80,0x3f80,0xbf163f4fbf733f80,0x3e9e
.quad 0x3e9e3e9ebf4f3f80,0xbf4f,0x3f73be9ebf163f80,0xbf4f,0x3f4fbf4fbe9e3f80,0x3e9e,0xbf8000003f80,0x3f80
.quad 0x3f803f803f803f80,0x3f80,0xbf4fbf16be9e0000,0xbf73,0x3e9ebe9ebf4fbf80,0x3f4f,0x3e9e3f733f4f0000,0xbf16
.quad 0xbf4fbf4f3e9e3f80,0x3e9e,0x3f800000bf800000,0x0,0xbf4f3f4f3e9ebf80,0xbe9e,0x3e9ebf733f4f0000,0x3f16
.quad 0x3e9e3e9ebf4f3f80,0xbf4f,0xbf4f3f16be9e0000,0x3f73,0x3f80bf803f80bf80,0xbf80,0xbf4f3f16be9e0000,0x3f73
.quad 0x3e9e3e9ebf4f3f80,0xbf4f,0x3e9ebf733f4f0000,0x3f16,0xbf4f3f4f3e9ebf80,0xbe9e,0x3f800000bf800000,0x0
.quad 0x3f803f803f803f80,0x3f80,0xbf16bf4fbf73bf80,0xbe9e,0xbe9e3e9e3f4f3f80,0xbf4f,0x3f733e9ebf16bf80,0x3f4f
.quad 0xbf4fbf4f3e9e3f80,0x3e9e,0x3f800000bf80,0xbf80,0x3f4fbf4fbe9e3f80,0x3e9e,0xbf733e9e3f16bf80,0x3f4f
.quad 0x3e9e3e9ebf4f3f80,0xbf4f,0x3f16bf4f3f73bf80,0xbe9e,0xbf803f80bf803f80,0x3f80,0x3f16bf4f3f73bf80,0xbe9e
.quad 0x3e9e3e9ebf4f3f80,0xbf4f,0xbf733e9e3f16bf80,0x3f4f,0x3f4fbf4fbe9e3f80,0x3e9e,0x3f800000bf80,0xbf80
.quad 0x3f803f803f803f80,0x3f80,0x3f4f3f163e9e0000,0x3f73,0x3e9ebe9ebf4fbf80,0x3f4f,0xbe9ebf73bf4f0000,0x3f16
.quad 0xbf4fbf4f3e9e3f80,0x3e9e,0xbf8000003f800000,0x0,0xbf4f3f4f3e9ebf80,0xbe9e,0xbe9e3f73bf4f0000,0xbf16
.quad 0x3e9e3e9ebf4f3f80,0xbf4f,0x3f4fbf163e9e0000,0xbf73,0x3f80bf803f80bf80,0xbf80,0x3f4fbf163e9e0000,0xbf73
.quad 0x3e9e3e9ebf4f3f80,0xbf4f,0xbe9e3f73bf4f0000,0xbf16,0xbf4f3f4f3e9ebf80,0xbe9e,0xbf8000003f800000,0x0
.quad 0x0,0x0,0xbf4fbf16be9e0000,0xbf73,0xbf73bf73bf160000,0xbf16,0xbe9ebf73bf4f0000,0x3f16
.quad 0x3f16bf16bf730000,0x3f73,0x3f800000bf800000,0x0,0x3f163f16bf730000,0xbf73,0xbe9e3f73bf4f0000,0xbf16
.quad 0xbf733f73bf160000,0x3f16,0xbf4f3f16be9e0000,0x3f73,0x0,0x0,0x3f4fbf163e9e0000,0xbf73
.quad 0x3f73bf733f160000,0xbf16,0x3e9ebf733f4f0000,0x3f16,0xbf16bf163f730000,0x3f73,0xbf8000003f800000,0x0
.quad 0x0,0x0,0xbf16bf4fbf73bf80,0xbe9e,0x3f733f733f160000,0x3f16,0xbf73be9e3f163f80,0xbf4f
.quad 0x3f16bf16bf730000,0x3f73,0x3f800000bf80,0xbf80,0xbf16bf163f730000,0x3f73,0x3f73be9ebf163f80,0xbf4f
.quad 0xbf733f73bf160000,0x3f16,0x3f16bf4f3f73bf80,0xbe9e,0x0,0x0,0xbf163f4fbf733f80,0x3e9e
.quad 0x3f73bf733f160000,0xbf16,0xbf733e9e3f16bf80,0x3f4f,0x3f163f16bf730000,0xbf73,0xbf8000003f80,0x3f80
.quad 0x0,0x0,0x3f4f3f163e9e0000,0x3f73,0xbf73bf73bf160000,0xbf16,0x3e9e3f733f4f0000,0xbf16
.quad 0x3f16bf16bf730000,0x3f73,0xbf8000003f800000,0x0,0x3f163f16bf730000,0xbf73,0x3e9ebf733f4f0000,0x3f16
.quad 0xbf733f73bf160000,0x3f16,0x3f4fbf163e9e0000,0xbf73,0x0,0x0,0xbf4f3f16be9e0000,0x3f73
.quad 0x3f73bf733f160000,0xbf16,0xbe9e3f73bf4f0000,0xbf16,0xbf16bf163f730000,0x3f73,0x3f800000bf800000,0x0
.quad 0x0,0x0,0x3f163f4f3f733f80,0x3e9e,0x3f733f733f160000,0x3f16,0x3f733e9ebf16bf80,0x3f4f
.quad 0x3f16bf16bf730000,0x3f73,0xbf8000003f80,0x3f80,0xbf16bf163f730000,0x3f73,0xbf733e9e3f16bf80,0x3f4f
.quad 0xbf733f73bf160000,0x3f16,0xbf163f4fbf733f80,0x3e9e,0x0,0x0,0x3f16bf4f3f73bf80,0xbe9e
.quad 0x3f73bf733f160000,0xbf16,0x3f73be9ebf163f80,0xbf4f,0x3f163f16bf730000,0xbf73,0x3f800000bf80,0xbf80
.quad 0x3f8000003f800000,0x3f8000003f800000,0x3f7ff35e3f800000,0x3f7f8e563f7fcd79,0x3f7fcd793f800000,0x3f7e39bc3f7f35f9,0x3f7f8e563f800000,0x3f7c03613f7e39bc
.quad 0x3f7f35f93f800000,0x3f78ed3c3f7cd925,0x3f7ec46d3f800000,0x3f74fa0b3f7b14be,0x3f7e39bc3f800000,0x3f702d4f3f78ed3c,0x3f7d95f43f800000,0x3f6a8b4b3f766377
.quad 0x3f7cd9253f800000,0x3f6419013f737871,0x3f7c03613f800000,0x3f5cdc293f702d4f,0x3f7b14be3f800000,0x3f54db313f6c835e,0x3f7a0d543f800000,0x3f4c1d353f687c12
.quad 0x3f78ed3c3f800000,0x3f42a9f73f641901,0x3f77b4933f800000,0x3f3889dc3f5f5be6,0x3f7663773f800000,0x3f2dc5e33f5a46a0,0x3f74fa0b3f800000,0x3f2267993f54db31
.quad 0x3f8000003f800000,0x3f8000003f800000,0x3f7ec46d3f7f35f9,0x3f7d95f43f7e39bc,0x3f7b14be3f7cd925,0x3f7663773f78ed3c,0x3f74fa0b3f78ed3c,0x3f6a8b4b3f702d4f
.quad 0x3f6c835e3f737871,0x3f5a46a03f641901,0x3f61c5983f6c835e,0x3f45e4033f54db31,0x3f54db313f641901,0x3f2dc5e33f42a9f7,0x3f45e4033f5a46a0,0x3f1260b23f2dc5e3
.quad 0x3f3504f33f4f1bbd,0x3ee871713f167918,0x3f2267993f42a9f7,0x3ea7bf253efa2c90,0x3f0e39da3f3504f3,0x3e47c5c23ec3ef15,0x3ef15aea3f26423a,0x3d7122833e8afa3e
.quad 0x3ec3ef153f167918,0xbda0af2a3e20305b,0x3e94a0313f05c277,0xbe5b73dc3d20cee7,0x3e47c5c23ee87171,0xbeb13641bda0af2a,0x3dc8bd363ec3ef15,0xbef15aeabe47c5c2
.quad 0x3f8000003f800000,0x3f8000003f800000,0x3f7c03613f7cd925,0x3f7a0d543f7b14be,0x3f702d4f3f737871,0x3f687c123f6c835e,0x3f5cdc293f641901,0x3f4c1d353f54db31
.quad 0x3f42a9f73f4f1bbd,0x3f26423a3f3504f3,0x3f2267993f3504f3,0x3ef15aea3f0e39da,0x3efa2c903f167918,0x3e8afa3e3ec3ef15,0x3ea7bf253ee87171,0x3d7122833e47c5c2
.quad 0x3e20305b3e9e377a,0xbe20305b00000000,0xbca0d6d63e20305b,0xbeba9be1be47c5c2,0xbe47c5c200000000,0xbf0e39dabec3ef15,0xbeba9be1be20305b,0xbf3889dcbf0e39da
.quad 0xbf05c277be9e377a,0xbf5a46a0bf3504f3,0xbf2a0c73bee87171,0xbf71decfbf54db31,0xbf490a88bf167918,0xbf7e39bcbf6c835e,0xbf61c598bf3504f3,0xbf7ec46dbf7b14be
.quad 0x3f8000003f800000,0x3f8000003f800000,0x3f77b4933f78ed3c,0x3f74fa0b3f766377,0x3f5f5be63f641901,0x3f54db313f5a46a0,0x3f3889dc3f42a9f7,0x3f2267993f2dc5e3
.quad 0x3f05c2773f167918,0x3ec3ef153ee87171,0x3e94a0313ec3ef15,0x3dc8bd363e47c5c2,0x3d20cee73e20305b,0xbe47c5c2bda0af2a,0xbe5b73dcbda0af2a,0xbef15aeabeb13641
.quad 0xbee87171be9e377a,0xbf3504f3bf167918,0xbf2a0c73bf05c277,0xbf61c598bf490a88,0xbf54db31bf3504f3,0xbf7b14bebf6c835e,0xbf71decfbf5a46a0,0xbf7ec46dbf7e39bc
.quad 0xbf7f35f9bf737871,0xbf6c835ebf7cd925,0xbf7c0361bf7f35f9,0xbf45e403bf687c12,0xbf687c12bf7cd925,0xbf0e39dabf42a9f7,0xbf45e403bf6c835e,0xbe94a031bf0e39da
.quad 0x3f8000003f800000,0x3f8000003f800000,0x3f7fe3943f7ffcd7,0x3f7f654e3f7fb10f,0x3f7f8e563f7ff35e,0x3f7d95f43f7ec46d,0x3f7f00593f7fe394,0x3f7a94213f7d3aac
.quad 0x3f7e39bc3f7fcd79,0x3f7663773f7b14be,0x3f7d3aac3f7fb10f,0x3f7109083f7853f8,0x3f7c03613f7f8e56,0x3f6a8b4b3f74fa0b,0x3f7a94213f7f654e,0x3f62f2193f710908
.quad 0x3f78ed3c3f7f35f9,0x3f5a46a03f6c835e,0x3f770f113f7f0059,0x3f50935b3f676bd8,0x3f74fa0b3f7ec46d,0x3f45e4033f61c598,0x3f72ae9e3f7e8238,0x3f3a45823f5b941a
.quad 0x3f702d4f3f7e39bc,0x3f2dc5e33f54db31,0x3f6d76aa3f7deafa,0x3f2074403f4d9f02,0x3f6a8b4b3f7d95f4,0x3f1260b23f45e403,0x3f676bd83f7d3aac,0x3f039c3d3f3daef9
.quad 0x3f8000003f800000,0x3f8000003f800000,0x3f7e82383f7f0059,0x3f7d3aac3f7deafa,0x3f7a0d543f7c0361,0x3f74fa0b3f77b493,0x3f72ae9e3f770f11,0x3f676bd83f6d76aa
.quad 0x3f687c123f702d4f,0x3f54db313f5f5be6,0x3f5b941a3f676bd8,0x3f3daef93f4d9f02,0x3f4c1d353f5cdc29,0x3f2267993f3889dc,0x3f3a45823f50935b,0x3f039c3d3f207440
.quad 0x3f26423a3f42a9f7,0x3ec3ef153f05c277,0x3f104f0e3f333bc6,0x3e78cfcc3ed1c759,0x3ef15aea3f226799,0x3dc8bd363e94a031,0x3ebf47d73f104f0e,0xbd48fb303e2a1c3f
.quad 0x3e8afa3e3efa2c90,0xbe47c5c23d20cee7,0x3e2a1c3f3ed1c759,0xbeac7cd4bdb4b86a,0x3d7122833ea7bf25,0xbef15aeabe5b73dc,0xbd48fb303e78cfcc,0xbf187fc0beac7cd4
.quad 0x3f8000003f800000,0x3f8000003f800000,0x3f7b8f2a3f7c7160,0x3f79805c3f7a9421,0x3f6e641a3f71decf,0x3f6655e73f6a8b4b,0x3f58f3c43f609384,0x3f4779bc3f50935b
.quad 0x3f3bfc8f3f490a88,0x3f1e7cf13f2dc5e3,0x3f187fc03f2beb4a,0x3edae8803f039c3d,0x3edf71083f0a04f8,0x3e5b73dc3ea7bf25,0x3e8622103ec8917e,0xbc20d8d23e0255f4
.quad 0x3da0af2a3e6f0c4d,0xbe6f0c4dbda0af2a,0xbddcbd0d3d8ca1f2,0xbee3f40dbe8fcefe,0xbe94a031bdc8bd36,0xbf226799bef15aea,0xbeece91abe862210,0xbf4a965ebf2456f1
.quad 0xbf1e7cf1bed65a92,0xbf687c12bf490a88,0xbf4105b8bf104f0e,0xbf7a9421bf653a48,0xbf5cdc29bf316e2c,0xbf7ff35ebf77b493,0xbf710908bf4d9f02,0xbf7853f8bf7fb10f
.quad 0x3f8000003f800000,0x3f8000003f800000,0x3f770f113f7853f8,0x3f743c413f75b1c9,0x3f5cdc293f61c598,0x3f5205d43f579b8c,0x3f333bc63f3daef9,0x3f1c81b93f28296a
.quad 0x3efa2c903f0e39da,0x3eb136413ed65a92,0x3e78cfcc3eac7cd4,0x3d48fb303e164083,0xbca0d6d63dc8bd36,0xbe814693be0c4cf7,0xbe8fcefebe164083,0xbf07e565bed1c759
.quad 0xbf05c277bec3ef15,0xbf42a9f7bf26423a,0xbf3a4582bf187fc0,0xbf6b8a3dbf563e03,0xbf61c598bf45e403,0xbf7ec46dbf74fa0b,0xbf79805cbf676bd8,0xbf7a9421bf7ffcd7
.quad 0xbf7fcd79bf7b14be,0xbf5f5be6bf766377,0xbf743c41bf7fb10f,0xbf2f9c32bf58f3c4,0xbf579b8cbf74fa0b,0xbedf7108bf2a0c73,0xbf2beb4abf5b941a,0xbe164083bedae880
.quad 0x0,0x0,0x3ca0d6d600000000,0x3d7122833d20cee7,0x3d20cee700000000,0x3df0b7723da0af2a,0x3d71228300000000,0x3e3403f13df0b772
.quad 0x3da0af2a00000000,0x3e6f0c4d3e20305b,0x3dc8bd3600000000,0x3e94a0313e47c5c2,0x3df0b77200000000,0x3eb136413e6f0c4d,0x3e0c4cf700000000,0x3ecd2ef33e8afa3e
.quad 0x3e20305b00000000,0x3ee871713e9e377a,0x3e3403f100000000,0x3f0172c33eb13641,0x3e47c5c200000000,0x3f0e39da3ec3ef15,0x3e5b73dc00000000,0x3f1a82a43ed65a92
.quad 0x3e6f0c4d00000000,0x3f26423a3ee87171,0x3e81469300000000,0x3f316e2c3efa2c90,0x3e8afa3e00000000,0x3f3bfc8f3f05c277,0x3e94a03100000000,0x3f45e4033f0e39da
.quad 0x0,0x0,0x3dc8bd363da0af2a,0x3e0c4cf73df0b772,0x3e47c5c23e20305b,0x3e8afa3e3e6f0c4d,0x3e94a0313e6f0c4d,0x3ecd2ef33eb13641
.quad 0x3ec3ef153e9e377a,0x3f05c2773ee87171,0x3ef15aea3ec3ef15,0x3f2267993f0e39da,0x3f0e39da3ee87171,0x3f3bfc8f3f26423a,0x3f2267993f05c277,0x3f5205d43f3bfc8f
.quad 0x3f3504f33f167918,0x3f6419013f4f1bbd,0x3f45e4033f26423a,0x3f71decf3f5f5be6,0x3f54db313f3504f3,0x3f7b14be3f6c835e,0x3f61c5983f42a9f7,0x3f7f8e563f766377
.quad 0x3f6c835e3f4f1bbd,0x3f7f35f93f7cd925,0x3f74fa0b3f5a46a0,0x3f7a0d543f7fcd79,0x3f7b14be3f641901,0x3f702d4f3f7f35f9,0x3f7ec46d3f6c835e,0x3f61c5983f7b14be
.quad 0x0,0x0,0x3e3403f13e20305b,0x3e5b73dc3e47c5c2,0x3eb136413e9e377a,0x3ed65a923ec3ef15,0x3f0172c33ee87171,0x3f1a82a43f0e39da
.quad 0x3f26423a3f167918,0x3f42a9f73f3504f3,0x3f45e4033f3504f3,0x3f61c5983f54db31,0x3f5f5be63f4f1bbd,0x3f7663773f6c835e,0x3f71decf3f641901,0x3f7f8e563f7b14be
.quad 0x3f7cd9253f737871,0x3f7cd9253f800000,0x3f7ff35e3f7cd925,0x3f6e641a3f7b14be,0x3f7b14be3f800000,0x3f54db313f6c835e,0x3f6e641a3f7cd925,0x3f316e2c3f54db31
.quad 0x3f5a46a03f737871,0x3f05c2773f3504f3,0x3f3f5cb53f641901,0x3ea7bf253f0e39da,0x3f1e7cf13f4f1bbd,0x3df0b7723ec3ef15,0x3ef15aea3f3504f3,0xbdc8bd363e47c5c2
.quad 0x0,0x0,0x3e8146933e6f0c4d,0x3e94a0313e8afa3e,0x3efa2c903ee87171,0x3f0e39da3f05c277,0x3f316e2c3f26423a,0x3f45e4033f3bfc8f
.quad 0x3f5a46a03f4f1bbd,0x3f6c835e3f641901,0x3f74fa0b3f6c835e,0x3f7ec46d3f7b14be,0x3f7fcd793f7cd925,0x3f7b14be3f7f35f9,0x3f7a0d543f7f35f9,0x3f61c5983f702d4f
.quad 0x3f6419013f737871,0x3f3504f33f4f1bbd,0x3f3f5cb53f5a46a0,0x3ef15aea3f1e7cf1,0x3f0e39da3f3504f3,0x3e47c5c23ec3ef15,0x3ea7bf253f05c277,0xbdc8bd363df0b772
.quad 0x3da0af2a3e9e377a,0xbec3ef15be20305b,0xbe3403f13da0af2a,0xbf226799bed65a92,0xbed65a92be20305b,0xbf54db31bf26423a,0xbf226799bec3ef15,0xbf74fa0bbf54db31
.quad 0x0,0x0,0x3cf13d4c3c20d8d2,0x3d8ca1f23d48fb30,0x3d7122833ca0d6d6,0x3e0c4cf73dc8bd36,0x3db4b86a3cf13d4c,0x3e519f653e164083
.quad 0x3df0b7723d20cee7,0x3e8afa3e3e47c5c2,0x3e1640833d48fb30,0x3eac7cd43e78cfcc,0x3e3403f13d712283,0x3ecd2ef33e94a031,0x3e519f653d8ca1f2,0x3eece91a3eac7cd4
.quad 0x3e6f0c4d3da0af2a,0x3f05c2773ec3ef15,0x3e8622103db4b86a,0x3f146eba3edae880,0x3e94a0313dc8bd36,0x3f2267993ef15aea,0x3ea2fd523ddcbd0d,0x3f2f9c323f039c3d
.quad 0x3eb136413df0b772,0x3f3bfc8f3f0e39da,0x3ebf47d73e0255f4,0x3f4779bc3f187fc0,0x3ecd2ef33e0c4cf7,0x3f5205d43f226799,0x3edae8803e164083,0x3f5b941a3f2beb4a
.quad 0x0,0x0,0x3ddcbd0d3db4b86a,0x3e1640833e0255f4,0x3e5b73dc3e3403f1,0x3e94a0313e814693,0x3ea2fd523e862210,0x3edae8803ebf47d7
.quad 0x3ed65a923eb13641,0x3f0e39da3efa2c90,0x3f039c3d3edae880,0x3f2beb4a3f187fc0,0x3f1a82a43f0172c3,0x3f45e4033f316e2c,0x3f2f9c323f146eba,0x3f5b941a3f4779bc
.quad 0x3f42a9f73f26423a,0x3f6c835e3f5a46a0,0x3f53731f3f36c9a9,0x3f7853f83f698690,0x3f61c5983f45e403,0x3f7ec46d3f74fa0b,0x3f6d76aa3f53731f,0x3f7fb10f3f7c7160
.quad 0x3f7663773f5f5be6,0x3f7b14be3f7fcd79,0x3f7c71603f698690,0x3f7109083f7f0059,0x3f7f8e563f71decf,0x3f61c5983f7a0d54,0x3f7fb10f3f7853f8,0x3f4d9f023f710908
.quad 0x0,0x0,0x3e3de7313e2a1c3f,0x3e6542e93e519f65,0x3eba9be13ea7bf25,0x3edf71083ecd2ef3,0x3f07e5653ef5c6c5,0x3f2074403f146eba
.quad 0x3f2dc5e33f1e7cf1,0x3f490a883f3bfc8f,0x3f4d9f023f3daef9,0x3f676bd83f5b941a,0x3f6655e73f579b8c,0x3f7a0d543f71decf,0x3f770f113f6b8a3d,0x3f7ffcd73f7deafa
.quad 0x3f7f35f93f78ed3c,0x3f78ed3c3f7f35f9,0x3f7e82383f7f654e,0x3f653a483f75b1c9,0x3f74fa0b3f7ec46d,0x3f45e4033f61c598,0x3f62f2193f770f11,0x3f1c81b93f444969
.quad 0x3f490a883f687c12,0x3ed65a923f1e7cf1,0x3f28296a3f53731f,0x3e519f653ee3f40d,0x3f0172c33f3889dc,0xbca0d6d63e814693,0x3eac7cd43f187fc0,0xbe78cfcc3d48fb30
.quad 0x0,0x0,0x3e8622103e78cfcc,0x3e996dba3e8fcefe,0x3f0172c33ef15aea,0x3f1260b23f0a04f8,0x3f36c9a93f2beb4a,0x3f4a965e3f4105b8
.quad 0x3f5f5be63f54db31,0x3f702d4f3f687c12,0x3f7853f83f710908,0x3f7fb10f3f7d3aac,0x3f7ff35e3f7ec46d,0x3f77b4933f7d95f4,0x3f75b1c93f7d3aac,0x3f58f3c43f698690
.quad 0x3f5a46a03f6c835e,0x3f26423a3f42a9f7,0x3f2f9c323f4d9f02,0x3ec8917e3f0c2124,0x3ef15aea3f226799,0x3dc8bd363e94a031,0x3e6542e93edae880,0xbe519f653c20d8d2
.quad 0xbd20cee73e47c5c2,0xbefa2c90be8afa3e,0xbe996dbabd48fb30,0xbf3a4582bf07e565,0xbf0a04f8be94a031,0xbf6655e7bf3f5cb5,0xbf3daef9bf039c3d,0xbf7d3aacbf676bd8
.quad 0x3f803f803f803f80,0x3f803f803f803f80,0x3f553f6d3f7b3f80,0x3e483ec43f0e3f35,0x3ec43f353f6d3f80,0xbf6dbf35bec40000,0xbe483ec43f553f80,0xbf0ebf6dbf7bbf35
.quad 0xbf3500003f353f80,0x3f350000bf35bf80,0xbf7bbec43f0e3f80,0x3f553f6d3e48bf35,0xbf6dbf353ec43f80,0xbec43f353f6d0000,0xbf0ebf6d3e483f80,0xbf7bbec43f553f35
.quad 0xbf8000003f80,0xbf8000003f80,0x3f0ebf6dbe483f80,0x3f7bbec4bf553f35,0x3f6dbf35bec43f80,0x3ec43f35bf6d0000,0x3f7bbec4bf0e3f80,0xbf553f6dbe48bf35
.quad 0x3f350000bf353f80,0xbf3500003f35bf80,0x3e483ec4bf553f80,0x3f0ebf6d3f7bbf35,0xbec43f35bf6d3f80,0x3f6dbf353ec40000,0xbf553f6dbf7b3f80,0xbe483ec4bf0e3f35
.quad 0x3f803f803f803f80,0x3f803f803f803f80,0xbf0ebec4be480000,0xbf7bbf6dbf55bf35,0xbec4bf35bf6dbf80,0x3f6d3f353ec40000,0x3f7b3f6d3f0e0000,0xbf55bec43e483f35
.quad 0xbf3500003f353f80,0x3f350000bf35bf80,0xbe48bf6dbf550000,0xbf0e3ec43f7b3f35,0x3f6d3f35bec4bf80,0x3ec4bf35bf6d0000,0xbf553ec43f7b0000,0xbe483f6d3f0ebf35
.quad 0xbf8000003f80,0xbf8000003f80,0x3f553ec4bf7b0000,0x3e483f6dbf0ebf35,0xbf6d3f353ec4bf80,0xbec4bf353f6d0000,0x3e48bf6d3f550000,0x3f0e3ec4bf7b3f35
.quad 0x3f350000bf353f80,0xbf3500003f35bf80,0xbf7b3f6dbf0e0000,0x3f55bec4be483f35,0x3ec4bf353f6dbf80,0xbf6d3f35bec40000,0x3f0ebec43e480000,0x3f7bbf6d3f55bf35
.quad 0x3f803f803f803f80,0x3f803f803f803f80,0xbf55bf6dbf7bbf80,0xbe48bec4bf0ebf35,0x3ec43f353f6d3f80,0xbf6dbf35bec40000,0x3e48bec4bf55bf80,0x3f0e3f6d3f7b3f35
.quad 0xbf3500003f353f80,0x3f350000bf35bf80,0x3f7b3ec4bf0ebf80,0xbf55bf6dbe483f35,0xbf6dbf353ec43f80,0xbec43f353f6d0000,0x3f0e3f6dbe48bf80,0x3f7b3ec4bf55bf35
.quad 0xbf8000003f80,0xbf8000003f80,0xbf0e3f6d3e48bf80,0xbf7b3ec43f55bf35,0x3f6dbf35bec43f80,0x3ec43f35bf6d0000,0xbf7b3ec43f0ebf80,0x3f55bf6d3e483f35
.quad 0x3f350000bf353f80,0xbf3500003f35bf80,0xbe48bec43f55bf80,0xbf0e3f6dbf7b3f35,0xbec43f35bf6d3f80,0x3f6dbf353ec40000,0x3f55bf6d3f7bbf80,0x3e48bec43f0ebf35
.quad 0x3f803f803f803f80,0x3f803f803f803f80,0x3f0e3ec43e480000,0x3f7b3f6d3f553f35,0xbec4bf35bf6dbf80,0x3f6d3f353ec40000,0xbf7bbf6dbf0e0000,0x3f553ec4be48bf35
.quad 0xbf3500003f353f80,0x3f350000bf35bf80,0x3e483f6d3f550000,0x3f0ebec4bf7bbf35,0x3f6d3f35bec4bf80,0x3ec4bf35bf6d0000,0x3f55bec4bf7b0000,0x3e48bf6dbf0e3f35
.quad 0xbf8000003f80,0xbf8000003f80,0xbf55bec43f7b0000,0xbe48bf6d3f0e3f35,0xbf6d3f353ec4bf80,0xbec4bf353f6d0000,0xbe483f6dbf550000,0xbf0ebec43f7bbf35
.quad 0x3f350000bf353f80,0xbf3500003f35bf80,0x3f7bbf6d3f0e0000,0xbf553ec43e48bf35,0x3ec4bf353f6dbf80,0xbf6d3f35bec40000,0xbf0e3ec4be480000,0xbf7b3f6dbf553f35
.quad 0x0,0x0,0x3f0e3ec43e480000,0x3f7b3f6d3f553f35,0x3f6d3f353ec40000,0x3ec43f353f6d3f80,0x3f7b3f6d3f0e0000,0xbf55bec43e483f35
.quad 0x3f353f803f350000,0xbf35bf80bf350000,0x3e483f6d3f550000,0x3f0ebec4bf7bbf35,0xbec43f353f6d0000,0x3f6d3f35bec4bf80,0xbf553ec43f7b0000,0xbe483f6d3f0ebf35
.quad 0xbf8000003f800000,0xbf8000003f800000,0xbf55bec43f7b0000,0xbe48bf6d3f0e3f35,0xbec4bf353f6d0000,0x3f6dbf35bec43f80,0x3e48bf6d3f550000,0x3f0e3ec4bf7b3f35
.quad 0x3f35bf803f350000,0xbf353f80bf350000,0x3f7bbf6d3f0e0000,0xbf553ec43e48bf35,0x3f6dbf353ec40000,0x3ec4bf353f6dbf80,0x3f0ebec43e480000,0x3f7bbf6d3f55bf35
.quad 0x0,0x0,0x3f553f6d3f7b3f80,0x3e483ec43f0e3f35,0xbf6dbf35bec40000,0xbec4bf35bf6dbf80,0x3e48bec4bf55bf80,0x3f0e3f6d3f7b3f35
.quad 0x3f353f803f350000,0xbf35bf80bf350000,0xbf7bbec43f0e3f80,0x3f553f6d3e48bf35,0x3ec4bf35bf6d0000,0xbf6dbf353ec43f80,0x3f0e3f6dbe48bf80,0x3f7b3ec4bf55bf35
.quad 0xbf8000003f800000,0xbf8000003f800000,0x3f0ebf6dbe483f80,0x3f7bbec4bf553f35,0x3ec43f35bf6d0000,0xbf6d3f353ec4bf80,0xbf7b3ec43f0ebf80,0x3f55bf6d3e483f35
.quad 0x3f35bf803f350000,0xbf353f80bf350000,0x3e483ec4bf553f80,0x3f0ebf6d3f7bbf35,0xbf6d3f35bec40000,0xbec43f35bf6d3f80,0x3f55bf6d3f7bbf80,0x3e48bec43f0ebf35
.quad 0x0,0x0,0xbf0ebec4be480000,0xbf7bbf6dbf55bf35,0x3f6d3f353ec40000,0x3ec43f353f6d3f80,0xbf7bbf6dbf0e0000,0x3f553ec4be48bf35
.quad 0x3f353f803f350000,0xbf35bf80bf350000,0xbe48bf6dbf550000,0xbf0e3ec43f7b3f35,0xbec43f353f6d0000,0x3f6d3f35bec4bf80,0x3f55bec4bf7b0000,0x3e48bf6dbf0e3f35
.quad 0xbf8000003f800000,0xbf8000003f800000,0x3f553ec4bf7b0000,0x3e483f6dbf0ebf35,0xbec4bf353f6d0000,0x3f6dbf35bec43f80,0xbe483f6dbf550000,0xbf0ebec43f7bbf35
.quad 0x3f35bf803f350000,0xbf353f80bf350000,0xbf7b3f6dbf0e0000,0x3f55bec4be483f35,0x3f6dbf353ec40000,0x3ec4bf353f6dbf80,0xbf0e3ec4be480000,0xbf7b3f6dbf553f35
.quad 0x0,0x0,0xbf55bf6dbf7bbf80,0xbe48bec4bf0ebf35,0xbf6dbf35bec40000,0xbec4bf35bf6dbf80,0xbe483ec43f553f80,0xbf0ebf6dbf7bbf35
.quad 0x3f353f803f350000,0xbf35bf80bf350000,0x3f7b3ec4bf0ebf80,0xbf55bf6dbe483f35,0x3ec4bf35bf6d0000,0xbf6dbf353ec43f80,0xbf0ebf6d3e483f80,0xbf7bbec43f553f35
.quad 0xbf8000003f800000,0xbf8000003f800000,0xbf0e3f6d3e48bf80,0xbf7b3ec43f55bf35,0x3ec43f35bf6d0000,0xbf6d3f353ec4bf80,0x3f7bbec4bf0e3f80,0xbf553f6dbe48bf35
.quad 0x3f35bf803f350000,0xbf353f80bf350000,0xbe48bec43f55bf80,0xbf0e3f6dbf7b3f35,0xbf6d3f35bec40000,0xbec43f35bf6d3f80,0xbf553f6dbf7b3f80,0xbe483ec4bf0e3f35
.quad 0x0,0x0,0xbf0ebec4be480000,0xbf7bbf6dbf55bf35,0xbf6dbf35bec40000,0xbec4bf35bf6dbf80,0xbf7bbf6dbf0e0000,0x3f553ec4be48bf35
.quad 0xbf35bf80bf350000,0x3f353f803f350000,0xbe48bf6dbf550000,0xbf0e3ec43f7b3f35,0x3ec4bf35bf6d0000,0xbf6dbf353ec43f80,0x3f55bec4bf7b0000,0x3e48bf6dbf0e3f35
.quad 0x3f800000bf800000,0x3f800000bf800000,0x3f553ec4bf7b0000,0x3e483f6dbf0ebf35,0x3ec43f35bf6d0000,0xbf6d3f353ec4bf80,0xbe483f6dbf550000,0xbf0ebec43f7bbf35
.quad 0xbf353f80bf350000,0x3f35bf803f350000,0xbf7b3f6dbf0e0000,0x3f55bec4be483f35,0xbf6d3f35bec40000,0xbec43f35bf6d3f80,0xbf0e3ec4be480000,0xbf7b3f6dbf553f35
.quad 0x0,0x0,0xbf55bf6dbf7bbf80,0xbe48bec4bf0ebf35,0x3f6d3f353ec40000,0x3ec43f353f6d3f80,0xbe483ec43f553f80,0xbf0ebf6dbf7bbf35
.quad 0xbf35bf80bf350000,0x3f353f803f350000,0x3f7b3ec4bf0ebf80,0xbf55bf6dbe483f35,0xbec43f353f6d0000,0x3f6d3f35bec4bf80,0xbf0ebf6d3e483f80,0xbf7bbec43f553f35
.quad 0x3f800000bf800000,0x3f800000bf800000,0xbf0e3f6d3e48bf80,0xbf7b3ec43f55bf35,0xbec4bf353f6d0000,0x3f6dbf35bec43f80,0x3f7bbec4bf0e3f80,0xbf553f6dbe48bf35
.quad 0xbf353f80bf350000,0x3f35bf803f350000,0xbe48bec43f55bf80,0xbf0e3f6dbf7b3f35,0x3f6dbf353ec40000,0x3ec4bf353f6dbf80,0xbf553f6dbf7b3f80,0xbe483ec4bf0e3f35
.quad 0x0,0x0,0x3f0e3ec43e480000,0x3f7b3f6d3f553f35,0xbf6dbf35bec40000,0xbec4bf35bf6dbf80,0x3f7b3f6d3f0e0000,0xbf55bec43e483f35
.quad 0xbf35bf80bf350000,0x3f353f803f350000,0x3e483f6d3f550000,0x3f0ebec4bf7bbf35,0x3ec4bf35bf6d0000,0xbf6dbf353ec43f80,0xbf553ec43f7b0000,0xbe483f6d3f0ebf35
.quad 0x3f800000bf800000,0x3f800000bf800000,0xbf55bec43f7b0000,0xbe48bf6d3f0e3f35,0x3ec43f35bf6d0000,0xbf6d3f353ec4bf80,0x3e48bf6d3f550000,0x3f0e3ec4bf7b3f35
.quad 0xbf353f80bf350000,0x3f35bf803f350000,0x3f7bbf6d3f0e0000,0xbf553ec43e48bf35,0xbf6d3f35bec40000,0xbec43f35bf6d3f80,0x3f0ebec43e480000,0x3f7bbf6d3f55bf35
.quad 0x0,0x0,0x3f553f6d3f7b3f80,0x3e483ec43f0e3f35,0x3f6d3f353ec40000,0x3ec43f353f6d3f80,0x3e48bec4bf55bf80,0x3f0e3f6d3f7b3f35
.quad 0xbf35bf80bf350000,0x3f353f803f350000,0xbf7bbec43f0e3f80,0x3f553f6d3e48bf35,0xbec43f353f6d0000,0x3f6d3f35bec4bf80,0x3f0e3f6dbe48bf80,0x3f7b3ec4bf55bf35
.quad 0x3f800000bf800000,0x3f800000bf800000,0x3f0ebf6dbe483f80,0x3f7bbec4bf553f35,0xbec4bf353f6d0000,0x3f6dbf35bec43f80,0xbf7b3ec43f0ebf80,0x3f55bf6d3e483f35
.quad 0xbf353f80bf350000,0x3f35bf803f350000,0x3e483ec4bf553f80,0x3f0ebf6d3f7bbf35,0x3f6dbf353ec40000,0x3ec4bf353f6dbf80,0x3f55bf6d3f7bbf80,0x3e48bec43f0ebf35
.quad 0xbf803f80bf803f80,0xbf803f80bf803f80,0xbf553f6dbf7b3f80,0xbe483ec4bf0e3f35,0xbec43f35bf6d3f80,0x3f6dbf353ec40000,0x3e483ec4bf553f80,0x3f0ebf6d3f7bbf35
.quad 0x3f350000bf353f80,0xbf3500003f35bf80,0x3f7bbec4bf0e3f80,0xbf553f6dbe48bf35,0x3f6dbf35bec43f80,0x3ec43f35bf6d0000,0x3f0ebf6dbe483f80,0x3f7bbec4bf553f35
.quad 0xbf8000003f80,0xbf8000003f80,0xbf0ebf6d3e483f80,0xbf7bbec43f553f35,0xbf6dbf353ec43f80,0xbec43f353f6d0000,0xbf7bbec43f0e3f80,0x3f553f6d3e48bf35
.quad 0xbf3500003f353f80,0x3f350000bf35bf80,0xbe483ec43f553f80,0xbf0ebf6dbf7bbf35,0x3ec43f353f6d3f80,0xbf6dbf35bec40000,0x3f553f6d3f7b3f80,0x3e483ec43f0e3f35
.quad 0xbf803f80bf803f80,0xbf803f80bf803f80,0x3f0ebec43e480000,0x3f7bbf6d3f55bf35,0x3ec4bf353f6dbf80,0xbf6d3f35bec40000,0xbf7b3f6dbf0e0000,0x3f55bec4be483f35
.quad 0x3f350000bf353f80,0xbf3500003f35bf80,0x3e48bf6d3f550000,0x3f0e3ec4bf7b3f35,0xbf6d3f353ec4bf80,0xbec4bf353f6d0000,0x3f553ec4bf7b0000,0x3e483f6dbf0ebf35
.quad 0xbf8000003f80,0xbf8000003f80,0xbf553ec43f7b0000,0xbe483f6d3f0ebf35,0x3f6d3f35bec4bf80,0x3ec4bf35bf6d0000,0xbe48bf6dbf550000,0xbf0e3ec43f7b3f35
.quad 0xbf3500003f353f80,0x3f350000bf35bf80,0x3f7b3f6d3f0e0000,0xbf55bec43e483f35,0xbec4bf35bf6dbf80,0x3f6d3f353ec40000,0xbf0ebec4be480000,0xbf7bbf6dbf55bf35
.quad 0xbf803f80bf803f80,0xbf803f80bf803f80,0x3f55bf6d3f7bbf80,0x3e48bec43f0ebf35,0xbec43f35bf6d3f80,0x3f6dbf353ec40000,0xbe48bec43f55bf80,0xbf0e3f6dbf7b3f35
.quad 0x3f350000bf353f80,0xbf3500003f35bf80,0xbf7b3ec43f0ebf80,0x3f55bf6d3e483f35,0x3f6dbf35bec43f80,0x3ec43f35bf6d0000,0xbf0e3f6d3e48bf80,0xbf7b3ec43f55bf35
.quad 0xbf8000003f80,0xbf8000003f80,0x3f0e3f6dbe48bf80,0x3f7b3ec4bf55bf35,0xbf6dbf353ec43f80,0xbec43f353f6d0000,0x3f7b3ec4bf0ebf80,0xbf55bf6dbe483f35
.quad 0xbf3500003f353f80,0x3f350000bf35bf80,0x3e48bec4bf55bf80,0x3f0e3f6d3f7b3f35,0x3ec43f353f6d3f80,0xbf6dbf35bec40000,0xbf55bf6dbf7bbf80,0xbe48bec4bf0ebf35
.quad 0xbf803f80bf803f80,0xbf803f80bf803f80,0xbf0e3ec4be480000,0xbf7b3f6dbf553f35,0x3ec4bf353f6dbf80,0xbf6d3f35bec40000,0x3f7bbf6d3f0e0000,0xbf553ec43e48bf35
.quad 0x3f350000bf353f80,0xbf3500003f35bf80,0xbe483f6dbf550000,0xbf0ebec43f7bbf35,0xbf6d3f353ec4bf80,0xbec4bf353f6d0000,0xbf55bec43f7b0000,0xbe48bf6d3f0e3f35
.quad 0xbf8000003f80,0xbf8000003f80,0x3f55bec4bf7b0000,0x3e48bf6dbf0e3f35,0x3f6d3f35bec4bf80,0x3ec4bf35bf6d0000,0x3e483f6d3f550000,0x3f0ebec4bf7bbf35
.quad 0xbf3500003f353f80,0x3f350000bf35bf80,0xbf7bbf6dbf0e0000,0x3f553ec4be48bf35,0xbec4bf35bf6dbf80,0x3f6d3f353ec40000,0x3f0e3ec43e480000,0x3f7b3f6d3f553f35
.quad 0x0,0x0,0xbf0e3ec4be480000,0xbf7b3f6dbf553f35,0xbf6d3f35bec40000,0xbec43f35bf6d3f80,0xbf7b3f6dbf0e0000,0x3f55bec4be483f35
.quad 0xbf353f80bf350000,0x3f35bf803f350000,0xbe483f6dbf550000,0xbf0ebec43f7bbf35,0x3ec43f35bf6d0000,0xbf6d3f353ec4bf80,0x3f553ec4bf7b0000,0x3e483f6dbf0ebf35
.quad 0x3f800000bf800000,0x3f800000bf800000,0x3f55bec4bf7b0000,0x3e48bf6dbf0e3f35,0x3ec4bf35bf6d0000,0xbf6dbf353ec43f80,0xbe48bf6dbf550000,0xbf0e3ec43f7b3f35
.quad 0xbf35bf80bf350000,0x3f353f803f350000,0xbf7bbf6dbf0e0000,0x3f553ec4be48bf35,0xbf6dbf35bec40000,0xbec4bf35bf6dbf80,0xbf0ebec4be480000,0xbf7bbf6dbf55bf35
.quad 0x0,0x0,0xbf553f6dbf7b3f80,0xbe483ec4bf0e3f35,0x3f6dbf353ec40000,0x3ec4bf353f6dbf80,0xbe48bec43f55bf80,0xbf0e3f6dbf7b3f35
.quad 0xbf353f80bf350000,0x3f35bf803f350000,0x3f7bbec4bf0e3f80,0xbf553f6dbe48bf35,0xbec4bf353f6d0000,0x3f6dbf35bec43f80,0xbf0e3f6d3e48bf80,0xbf7b3ec43f55bf35
.quad 0x3f800000bf800000,0x3f800000bf800000,0xbf0ebf6d3e483f80,0xbf7bbec43f553f35,0xbec43f353f6d0000,0x3f6d3f35bec4bf80,0x3f7b3ec4bf0ebf80,0xbf55bf6dbe483f35
.quad 0xbf35bf80bf350000,0x3f353f803f350000,0xbe483ec43f553f80,0xbf0ebf6dbf7bbf35,0x3f6d3f353ec40000,0x3ec43f353f6d3f80,0xbf55bf6dbf7bbf80,0xbe48bec4bf0ebf35
.quad 0x0,0x0,0x3f0ebec43e480000,0x3f7bbf6d3f55bf35,0xbf6d3f35bec40000,0xbec43f35bf6d3f80,0x3f7bbf6d3f0e0000,0xbf553ec43e48bf35
.quad 0xbf353f80bf350000,0x3f35bf803f350000,0x3e48bf6d3f550000,0x3f0e3ec4bf7b3f35,0x3ec43f35bf6d0000,0xbf6d3f353ec4bf80,0xbf55bec43f7b0000,0xbe48bf6d3f0e3f35
.quad 0x3f800000bf800000,0x3f800000bf800000,0xbf553ec43f7b0000,0xbe483f6d3f0ebf35,0x3ec4bf35bf6d0000,0xbf6dbf353ec43f80,0x3e483f6d3f550000,0x3f0ebec4bf7bbf35
.quad 0xbf35bf80bf350000,0x3f353f803f350000,0x3f7b3f6d3f0e0000,0xbf55bec43e483f35,0xbf6dbf35bec40000,0xbec4bf35bf6dbf80,0x3f0e3ec43e480000,0x3f7b3f6d3f553f35
.quad 0x0,0x0,0x3f55bf6d3f7bbf80,0x3e48bec43f0ebf35,0x3f6dbf353ec40000,0x3ec4bf353f6dbf80,0x3e483ec4bf553f80,0x3f0ebf6d3f7bbf35
.quad 0xbf353f80bf350000,0x3f35bf803f350000,0xbf7b3ec43f0ebf80,0x3f55bf6d3e483f35,0xbec4bf353f6d0000,0x3f6dbf35bec43f80,0x3f0ebf6dbe483f80,0x3f7bbec4bf553f35
.quad 0x3f800000bf800000,0x3f800000bf800000,0x3f0e3f6dbe48bf80,0x3f7b3ec4bf55bf35,0xbec43f353f6d0000,0x3f6d3f35bec4bf80,0xbf7bbec43f0e3f80,0x3f553f6d3e48bf35
.quad 0xbf35bf80bf350000,0x3f353f803f350000,0x3e48bec4bf55bf80,0x3f0e3f6d3f7b3f35,0x3f6d3f353ec40000,0x3ec43f353f6d3f80,0x3f553f6d3f7b3f80,0x3e483ec43f0e3f35
.quad 0x3f80bf803f80bf80,0x3f80bf803f80bf80,0x3f55bf6d3f7bbf80,0x3e48bec43f0ebf35,0x3ec4bf353f6dbf80,0xbf6d3f35bec40000,0xbe48bec43f55bf80,0xbf0e3f6dbf7b3f35
.quad 0xbf3500003f35bf80,0x3f350000bf353f80,0xbf7b3ec43f0ebf80,0x3f55bf6d3e483f35,0xbf6d3f353ec4bf80,0xbec4bf353f6d0000,0xbf0e3f6d3e48bf80,0xbf7b3ec43f55bf35
.quad 0x3f800000bf80,0x3f800000bf80,0x3f0e3f6dbe48bf80,0x3f7b3ec4bf55bf35,0x3f6d3f35bec4bf80,0x3ec4bf35bf6d0000,0x3f7b3ec4bf0ebf80,0xbf55bf6dbe483f35
.quad 0x3f350000bf35bf80,0xbf3500003f353f80,0x3e48bec4bf55bf80,0x3f0e3f6d3f7b3f35,0xbec4bf35bf6dbf80,0x3f6d3f353ec40000,0xbf55bf6dbf7bbf80,0xbe48bec4bf0ebf35
.quad 0x3f80bf803f80bf80,0x3f80bf803f80bf80,0xbf0e3ec4be480000,0xbf7b3f6dbf553f35,0xbec43f35bf6d3f80,0x3f6dbf353ec40000,0x3f7bbf6d3f0e0000,0xbf553ec43e48bf35
.quad 0xbf3500003f35bf80,0x3f350000bf353f80,0xbe483f6dbf550000,0xbf0ebec43f7bbf35,0x3f6dbf35bec43f80,0x3ec43f35bf6d0000,0xbf55bec43f7b0000,0xbe48bf6d3f0e3f35
.quad 0x3f800000bf80,0x3f800000bf80,0x3f55bec4bf7b0000,0x3e48bf6dbf0e3f35,0xbf6dbf353ec43f80,0xbec43f353f6d0000,0x3e483f6d3f550000,0x3f0ebec4bf7bbf35
.quad 0x3f350000bf35bf80,0xbf3500003f353f80,0xbf7bbf6dbf0e0000,0x3f553ec4be48bf35,0x3ec43f353f6d3f80,0xbf6dbf35bec40000,0x3f0e3ec43e480000,0x3f7b3f6d3f553f35
.quad 0x3f80bf803f80bf80,0x3f80bf803f80bf80,0xbf553f6dbf7b3f80,0xbe483ec4bf0e3f35,0x3ec4bf353f6dbf80,0xbf6d3f35bec40000,0x3e483ec4bf553f80,0x3f0ebf6d3f7bbf35
.quad 0xbf3500003f35bf80,0x3f350000bf353f80,0x3f7bbec4bf0e3f80,0xbf553f6dbe48bf35,0xbf6d3f353ec4bf80,0xbec4bf353f6d0000,0x3f0ebf6dbe483f80,0x3f7bbec4bf553f35
.quad 0x3f800000bf80,0x3f800000bf80,0xbf0ebf6d3e483f80,0xbf7bbec43f553f35,0x3f6d3f35bec4bf80,0x3ec4bf35bf6d0000,0xbf7bbec43f0e3f80,0x3f553f6d3e48bf35
.quad 0x3f350000bf35bf80,0xbf3500003f353f80,0xbe483ec43f553f80,0xbf0ebf6dbf7bbf35,0xbec4bf35bf6dbf80,0x3f6d3f353ec40000,0x3f553f6d3f7b3f80,0x3e483ec43f0e3f35
.quad 0x3f80bf803f80bf80,0x3f80bf803f80bf80,0x3f0ebec43e480000,0x3f7bbf6d3f55bf35,0xbec43f35bf6d3f80,0x3f6dbf353ec40000,0xbf7b3f6dbf0e0000,0x3f55bec4be483f35
.quad 0xbf3500003f35bf80,0x3f350000bf353f80,0x3e48bf6d3f550000,0x3f0e3ec4bf7b3f35,0x3f6dbf35bec43f80,0x3ec43f35bf6d0000,0x3f553ec4bf7b0000,0x3e483f6dbf0ebf35
.quad 0x3f800000bf80,0x3f800000bf80,0xbf553ec43f7b0000,0xbe483f6d3f0ebf35,0xbf6dbf353ec43f80,0xbec43f353f6d0000,0xbe48bf6dbf550000,0xbf0e3ec43f7b3f35
.quad 0x3f350000bf35bf80,0xbf3500003f353f80,0x3f7b3f6d3f0e0000,0xbf55bec43e483f35,0x3ec43f353f6d3f80,0xbf6dbf35bec40000,0xbf0ebec4be480000,0xbf7bbf6dbf55bf35
.quad 0x3f8000003f80,0x3f8000003f80,0x3f8000003f800000,0x3f8000003f800000,0x3ec43f6d00003f80,0x3f6d3ec43f353f35,0x3f6dbec43f800000,0x3ec4bf6d3f35bf35
.quad 0x3f353f3500003f80,0x3f35bf353f800000,0x3f35bf353f800000,0xbf35bf350000bf80,0x3f6d3ec400003f80,0xbec4bf6d3f35bf35,0x3ec4bf6d3f800000,0xbf6d3ec4bf35bf35
.quad 0x3f80000000003f80,0xbf8000000000bf80,0xbf803f800000,0x3f80bf800000,0x3f6dbec400003f80,0xbec43f6dbf35bf35,0xbec4bf6d3f800000,0x3f6d3ec4bf353f35
.quad 0x3f35bf3500003f80,0x3f353f35bf800000,0xbf35bf353f800000,0x3f35bf3500003f80,0x3ec4bf6d00003f80,0x3f6dbec4bf353f35,0xbf6dbec43f800000,0xbec4bf6d3f353f35
.quad 0x3f8000003f80,0x3f8000003f80,0x3f8000003f800000,0x3f8000003f800000,0x3f6dbec43f800000,0x3ec4bf6d3f35bf35,0xbec4bf6d0000bf80,0xbf6dbec4bf35bf35
.quad 0xbf35bf350000bf80,0xbf353f35bf800000,0xbf353f35bf800000,0x3f353f3500003f80,0xbec43f6dbf800000,0x3f6dbec43f353f35,0x3f6d3ec400003f80,0xbec4bf6d3f35bf35
.quad 0x3f80000000003f80,0xbf8000000000bf80,0xbf803f800000,0x3f80bf800000,0xbec4bf6d3f800000,0x3f6d3ec4bf353f35,0xbf6d3ec40000bf80,0x3ec4bf6d3f353f35
.quad 0xbf353f350000bf80,0xbf35bf353f800000,0x3f353f35bf800000,0xbf353f350000bf80,0x3f6d3ec4bf800000,0x3ec43f6dbf35bf35,0x3ec4bf6d00003f80,0x3f6dbec4bf353f35
.quad 0x3f8000003f80,0x3f8000003f80,0x3f8000003f800000,0x3f8000003f800000,0xbec4bf6d0000bf80,0xbf6dbec4bf35bf35,0xbf6d3ec4bf800000,0xbec43f6dbf353f35
.quad 0x3f353f3500003f80,0x3f35bf353f800000,0x3f35bf353f800000,0xbf35bf350000bf80,0xbf6dbec40000bf80,0x3ec43f6dbf353f35,0xbec43f6dbf800000,0x3f6dbec43f353f35
.quad 0x3f80000000003f80,0xbf8000000000bf80,0xbf803f800000,0x3f80bf800000,0xbf6d3ec40000bf80,0x3ec4bf6d3f353f35,0x3ec43f6dbf800000,0xbf6dbec43f35bf35
.quad 0x3f35bf3500003f80,0x3f353f35bf800000,0xbf35bf353f800000,0x3f35bf3500003f80,0xbec43f6d0000bf80,0xbf6d3ec43f35bf35,0x3f6d3ec4bf800000,0x3ec43f6dbf35bf35
.quad 0x3f8000003f80,0x3f8000003f80,0x3f8000003f800000,0x3f8000003f800000,0xbf6d3ec4bf800000,0xbec43f6dbf353f35,0x3ec43f6d00003f80,0x3f6d3ec43f353f35
.quad 0xbf35bf350000bf80,0xbf353f35bf800000,0xbf353f35bf800000,0x3f353f3500003f80,0x3ec4bf6d3f800000,0xbf6d3ec4bf35bf35,0xbf6dbec40000bf80,0x3ec43f6dbf353f35
.quad 0x3f80000000003f80,0xbf8000000000bf80,0xbf803f800000,0x3f80bf800000,0x3ec43f6dbf800000,0xbf6dbec43f35bf35,0x3f6dbec400003f80,0xbec43f6dbf35bf35
.quad 0xbf353f350000bf80,0xbf35bf353f800000,0x3f353f35bf800000,0xbf353f350000bf80,0xbf6dbec43f800000,0xbec4bf6d3f353f35,0xbec43f6d0000bf80,0xbf6d3ec43f35bf35
.quad 0xbf8000003f80,0xbf8000003f80,0xbf8000003f800000,0xbf8000003f800000,0xbec4bf6d00003f80,0xbf6dbec43f353f35,0xbf6d3ec43f800000,0xbec43f6d3f35bf35
.quad 0xbf35bf3500003f80,0xbf353f353f800000,0xbf353f353f800000,0x3f353f350000bf80,0xbf6dbec400003f80,0x3ec43f6d3f35bf35,0xbec43f6d3f800000,0x3f6dbec4bf35bf35
.quad 0xbf80000000003f80,0x3f8000000000bf80,0x3f803f800000,0xbf80bf800000,0xbf6d3ec400003f80,0x3ec4bf6dbf35bf35,0x3ec43f6d3f800000,0xbf6dbec4bf353f35
.quad 0xbf353f3500003f80,0xbf35bf35bf800000,0x3f353f353f800000,0xbf353f3500003f80,0xbec43f6d00003f80,0xbf6d3ec4bf353f35,0x3f6d3ec43f800000,0x3ec43f6d3f353f35
.quad 0xbf8000003f80,0xbf8000003f80,0xbf8000003f800000,0xbf8000003f800000,0xbf6d3ec43f800000,0xbec43f6d3f35bf35,0x3ec43f6d0000bf80,0x3f6d3ec4bf35bf35
.quad 0x3f353f350000bf80,0x3f35bf35bf800000,0x3f35bf35bf800000,0xbf35bf3500003f80,0x3ec4bf6dbf800000,0xbf6d3ec43f353f35,0xbf6dbec400003f80,0x3ec43f6d3f35bf35
.quad 0xbf80000000003f80,0x3f8000000000bf80,0x3f803f800000,0xbf80bf800000,0x3ec43f6d3f800000,0xbf6dbec4bf353f35,0x3f6dbec40000bf80,0xbec43f6d3f353f35
.quad 0x3f35bf350000bf80,0x3f353f353f800000,0xbf35bf35bf800000,0x3f35bf350000bf80,0xbf6dbec4bf800000,0xbec4bf6dbf35bf35,0xbec43f6d00003f80,0xbf6d3ec4bf353f35
.quad 0xbf8000003f80,0xbf8000003f80,0xbf8000003f800000,0xbf8000003f800000,0x3ec43f6d0000bf80,0x3f6d3ec4bf35bf35,0x3f6dbec4bf800000,0x3ec4bf6dbf353f35
.quad 0xbf35bf3500003f80,0xbf353f353f800000,0xbf353f353f800000,0x3f353f350000bf80,0x3f6d3ec40000bf80,0xbec4bf6dbf353f35,0x3ec4bf6dbf800000,0xbf6d3ec43f353f35
.quad 0xbf80000000003f80,0x3f8000000000bf80,0x3f803f800000,0xbf80bf800000,0x3f6dbec40000bf80,0xbec43f6d3f353f35,0xbec4bf6dbf800000,0x3f6d3ec43f35bf35
.quad 0xbf353f3500003f80,0xbf35bf35bf800000,0x3f353f353f800000,0xbf353f3500003f80,0x3ec4bf6d0000bf80,0x3f6dbec43f35bf35,0xbf6dbec4bf800000,0xbec4bf6dbf35bf35
.quad 0xbf8000003f80,0xbf8000003f80,0xbf8000003f800000,0xbf8000003f800000,0x3f6dbec4bf800000,0x3ec4bf6dbf353f35,0xbec4bf6d00003f80,0xbf6dbec43f353f35
.quad 0x3f353f350000bf80,0x3f35bf35bf800000,0x3f35bf35bf800000,0xbf35bf3500003f80,0xbec43f6d3f800000,0x3f6dbec4bf35bf35,0x3f6d3ec40000bf80,0xbec4bf6dbf353f35
.quad 0xbf80000000003f80,0x3f8000000000bf80,0x3f803f800000,0xbf80bf800000,0xbec4bf6dbf800000,0x3f6d3ec43f35bf35,0xbf6d3ec400003f80,0x3ec4bf6dbf35bf35
.quad 0x3f35bf350000bf80,0x3f353f353f800000,0xbf35bf35bf800000,0x3f35bf350000bf80,0x3f6d3ec43f800000,0x3ec43f6d3f353f35,0x3ec4bf6d0000bf80,0x3f6dbec43f35bf35
.quad 0x3f8000003f80,0x3f8000003f80,0x3f8000003f800000,0x3f8000003f800000,0xbec43f6d00003f80,0x3ec4bf6d0000bf80,0x3f6d3ec43f800000,0xbf6dbec4bf800000
.quad 0xbf353f3500003f80,0xbf353f3500003f80,0x3f353f353f800000,0x3f353f353f800000,0xbf6d3ec400003f80,0x3f6dbec40000bf80,0x3ec43f6d3f800000,0xbec4bf6dbf800000
.quad 0xbf80000000003f80,0xbf80000000003f80,0x3f803f800000,0x3f803f800000,0xbf6dbec400003f80,0x3f6d3ec40000bf80,0xbec43f6d3f800000,0x3ec4bf6dbf800000
.quad 0xbf35bf3500003f80,0xbf35bf3500003f80,0xbf353f353f800000,0xbf353f353f800000,0xbec4bf6d00003f80,0x3ec43f6d0000bf80,0xbf6d3ec43f800000,0x3f6dbec4bf800000
.quad 0x3f8000003f80,0x3f8000003f80,0x3f8000003f800000,0x3f8000003f800000,0xbf6d3ec4bf353f35,0x3f6dbec43f35bf35,0x3ec43f6d3f353f35,0xbec4bf6dbf35bf35
.quad 0xbf35bf35bf800000,0xbf35bf35bf800000,0xbf353f3500003f80,0xbf353f3500003f80,0x3ec4bf6dbf35bf35,0xbec43f6d3f353f35,0xbf6dbec4bf353f35,0x3f6d3ec43f35bf35
.quad 0x3f8000000000bf80,0x3f8000000000bf80,0xbf80bf800000,0xbf80bf800000,0x3ec43f6d3f35bf35,0xbec4bf6dbf353f35,0x3f6dbec4bf35bf35,0xbf6d3ec43f353f35
.quad 0xbf353f353f800000,0xbf353f353f800000,0x3f353f350000bf80,0x3f353f350000bf80,0xbf6dbec43f353f35,0x3f6d3ec4bf35bf35,0xbec43f6d3f35bf35,0x3ec4bf6dbf353f35
.quad 0x3f8000003f80,0x3f8000003f80,0x3f8000003f800000,0x3f8000003f800000,0xbf6dbec4bf800000,0x3f6d3ec43f800000,0xbec43f6d00003f80,0x3ec4bf6d0000bf80
.quad 0x3f35bf350000bf80,0x3f35bf350000bf80,0xbf35bf35bf800000,0xbf35bf35bf800000,0x3ec43f6d3f800000,0xbec4bf6dbf800000,0x3f6dbec40000bf80,0xbf6d3ec400003f80
.quad 0xbf80000000003f80,0xbf80000000003f80,0x3f803f800000,0x3f803f800000,0x3ec4bf6dbf800000,0xbec43f6d3f800000,0xbf6dbec400003f80,0x3f6d3ec40000bf80
.quad 0x3f353f350000bf80,0x3f353f350000bf80,0x3f35bf35bf800000,0x3f35bf35bf800000,0xbf6d3ec43f800000,0x3f6dbec4bf800000,0x3ec43f6d0000bf80,0xbec4bf6d00003f80
.quad 0x3f8000003f80,0x3f8000003f80,0x3f8000003f800000,0x3f8000003f800000,0xbec4bf6dbf35bf35,0x3ec43f6d3f353f35,0xbf6d3ec4bf353f35,0x3f6dbec43f35bf35
.quad 0x3f353f353f800000,0x3f353f353f800000,0x3f35bf350000bf80,0x3f35bf350000bf80,0xbf6dbec4bf353f35,0x3f6d3ec43f35bf35,0xbec43f6d3f353f35,0x3ec4bf6dbf35bf35
.quad 0x3f8000000000bf80,0x3f8000000000bf80,0xbf80bf800000,0xbf80bf800000,0xbf6d3ec43f353f35,0x3f6dbec4bf35bf35,0x3ec43f6d3f35bf35,0xbec4bf6dbf353f35
.quad 0x3f35bf35bf800000,0x3f35bf35bf800000,0xbf35bf3500003f80,0xbf35bf3500003f80,0xbec43f6d3f35bf35,0x3ec4bf6dbf353f35,0x3f6d3ec4bf35bf35,0xbf6dbec43f353f35
.quad 0xbf8000003f80,0xbf8000003f80,0xbf8000003f800000,0xbf8000003f800000,0x3ec4bf6d00003f80,0xbec43f6d0000bf80,0xbf6dbec43f800000,0x3f6d3ec4bf800000
.quad 0x3f35bf3500003f80,0x3f35bf3500003f80,0xbf35bf353f800000,0xbf35bf353f800000,0x3f6dbec400003f80,0xbf6d3ec40000bf80,0xbec4bf6d3f800000,0x3ec43f6dbf800000
.quad 0x3f80000000003f80,0x3f80000000003f80,0xbf803f800000,0xbf803f800000,0x3f6d3ec400003f80,0xbf6dbec40000bf80,0x3ec4bf6d3f800000,0xbec43f6dbf800000
.quad 0x3f353f3500003f80,0x3f353f3500003f80,0x3f35bf353f800000,0x3f35bf353f800000,0x3ec43f6d00003f80,0xbec4bf6d0000bf80,0x3f6dbec43f800000,0xbf6d3ec4bf800000
.quad 0xbf8000003f80,0xbf8000003f80,0xbf8000003f800000,0xbf8000003f800000,0x3f6dbec4bf353f35,0xbf6d3ec43f35bf35,0xbec4bf6d3f353f35,0x3ec43f6dbf35bf35
.quad 0x3f353f35bf800000,0x3f353f35bf800000,0x3f35bf3500003f80,0x3f35bf3500003f80,0xbec43f6dbf35bf35,0x3ec4bf6d3f353f35,0x3f6d3ec4bf353f35,0xbf6dbec43f35bf35
.quad 0xbf8000000000bf80,0xbf8000000000bf80,0x3f80bf800000,0x3f80bf800000,0xbec4bf6d3f35bf35,0x3ec43f6dbf353f35,0xbf6d3ec4bf35bf35,0x3f6dbec43f353f35
.quad 0x3f35bf353f800000,0x3f35bf353f800000,0xbf35bf350000bf80,0xbf35bf350000bf80,0x3f6d3ec43f353f35,0xbf6dbec4bf35bf35,0x3ec4bf6d3f35bf35,0xbec43f6dbf353f35
.quad 0xbf8000003f80,0xbf8000003f80,0xbf8000003f800000,0xbf8000003f800000,0x3f6d3ec4bf800000,0xbf6dbec43f800000,0x3ec4bf6d00003f80,0xbec43f6d0000bf80
.quad 0xbf353f350000bf80,0xbf353f350000bf80,0x3f353f35bf800000,0x3f353f35bf800000,0xbec4bf6d3f800000,0x3ec43f6dbf800000,0xbf6d3ec40000bf80,0x3f6dbec400003f80
.quad 0x3f80000000003f80,0x3f80000000003f80,0xbf803f800000,0xbf803f800000,0xbec43f6dbf800000,0x3ec4bf6d3f800000,0x3f6d3ec400003f80,0xbf6dbec40000bf80
.quad 0xbf35bf350000bf80,0xbf35bf350000bf80,0xbf353f35bf800000,0xbf353f35bf800000,0x3f6dbec43f800000,0xbf6d3ec4bf800000,0xbec4bf6d0000bf80,0x3ec43f6d00003f80
.quad 0xbf8000003f80,0xbf8000003f80,0xbf8000003f800000,0xbf8000003f800000,0x3ec43f6dbf35bf35,0xbec4bf6d3f353f35,0x3f6dbec4bf353f35,0xbf6d3ec43f35bf35
.quad 0xbf35bf353f800000,0xbf35bf353f800000,0xbf353f350000bf80,0xbf353f350000bf80,0x3f6d3ec4bf353f35,0xbf6dbec43f35bf35,0x3ec4bf6d3f353f35,0xbec43f6dbf35bf35
.quad 0xbf8000000000bf80,0xbf8000000000bf80,0x3f80bf800000,0x3f80bf800000,0x3f6dbec43f353f35,0xbf6d3ec4bf35bf35,0xbec4bf6d3f35bf35,0x3ec43f6dbf353f35
.quad 0xbf353f35bf800000,0xbf353f35bf800000,0x3f353f3500003f80,0x3f353f3500003f80,0x3ec4bf6d3f35bf35,0xbec43f6dbf353f35,0xbf6dbec4bf35bf35,0x3f6d3ec43f353f35
.quad 0x3f8000003f80,0x3f8000003f80,0x3f8000003f800000,0x3f8000003f800000,0xbec43f6d00003f80,0xbf6d3ec4bf353f35,0x3f6d3ec43f800000,0x3ec43f6d3f353f35
.quad 0xbf353f3500003f80,0xbf35bf35bf800000,0x3f353f353f800000,0xbf353f3500003f80,0xbf6d3ec400003f80,0x3ec4bf6dbf35bf35,0x3ec43f6d3f800000,0xbf6dbec4bf353f35
.quad 0xbf80000000003f80,0x3f8000000000bf80,0x3f803f800000,0xbf80bf800000,0xbf6dbec400003f80,0x3ec43f6d3f35bf35,0xbec43f6d3f800000,0x3f6dbec4bf35bf35
.quad 0xbf35bf3500003f80,0xbf353f353f800000,0xbf353f353f800000,0x3f353f350000bf80,0xbec4bf6d00003f80,0xbf6dbec43f353f35,0xbf6d3ec43f800000,0xbec43f6d3f35bf35
.quad 0x3f8000003f80,0x3f8000003f80,0x3f8000003f800000,0x3f8000003f800000,0xbf6dbec4bf800000,0xbec4bf6dbf35bf35,0xbec43f6d00003f80,0xbf6d3ec4bf353f35
.quad 0x3f35bf350000bf80,0x3f353f353f800000,0xbf35bf35bf800000,0x3f35bf350000bf80,0x3ec43f6d3f800000,0xbf6dbec4bf353f35,0x3f6dbec40000bf80,0xbec43f6d3f353f35
.quad 0xbf80000000003f80,0x3f8000000000bf80,0x3f803f800000,0xbf80bf800000,0x3ec4bf6dbf800000,0xbf6d3ec43f353f35,0xbf6dbec400003f80,0x3ec43f6d3f35bf35
.quad 0x3f353f350000bf80,0x3f35bf35bf800000,0x3f35bf35bf800000,0xbf35bf3500003f80,0xbf6d3ec43f800000,0xbec43f6d3f35bf35,0x3ec43f6d0000bf80,0x3f6d3ec4bf35bf35
.quad 0x3f8000003f80,0x3f8000003f80,0x3f8000003f800000,0x3f8000003f800000,0x3ec4bf6d0000bf80,0x3f6dbec43f35bf35,0xbf6dbec4bf800000,0xbec4bf6dbf35bf35
.quad 0xbf353f3500003f80,0xbf35bf35bf800000,0x3f353f353f800000,0xbf353f3500003f80,0x3f6dbec40000bf80,0xbec43f6d3f353f35,0xbec4bf6dbf800000,0x3f6d3ec43f35bf35
.quad 0xbf80000000003f80,0x3f8000000000bf80,0x3f803f800000,0xbf80bf800000,0x3f6d3ec40000bf80,0xbec4bf6dbf353f35,0x3ec4bf6dbf800000,0xbf6d3ec43f353f35
.quad 0xbf35bf3500003f80,0xbf353f353f800000,0xbf353f353f800000,0x3f353f350000bf80,0x3ec43f6d0000bf80,0x3f6d3ec4bf35bf35,0x3f6dbec4bf800000,0x3ec4bf6dbf353f35
.quad 0x3f8000003f80,0x3f8000003f80,0x3f8000003f800000,0x3f8000003f800000,0x3f6d3ec43f800000,0x3ec43f6d3f353f35,0x3ec4bf6d0000bf80,0x3f6dbec43f35bf35
.quad 0x3f35bf350000bf80,0x3f353f353f800000,0xbf35bf35bf800000,0x3f35bf350000bf80,0xbec4bf6dbf800000,0x3f6d3ec43f35bf35,0xbf6d3ec400003f80,0x3ec4bf6dbf35bf35
.quad 0xbf80000000003f80,0x3f8000000000bf80,0x3f803f800000,0xbf80bf800000,0xbec43f6d3f800000,0x3f6dbec4bf35bf35,0x3f6d3ec40000bf80,0xbec4bf6dbf353f35
.quad 0x3f353f350000bf80,0x3f35bf35bf800000,0x3f35bf35bf800000,0xbf35bf3500003f80,0x3f6dbec4bf800000,0x3ec4bf6dbf353f35,0xbec4bf6d00003f80,0xbf6dbec43f353f35
.quad 0xbf8000003f80,0xbf8000003f80,0xbf8000003f800000,0xbf8000003f800000,0x3ec4bf6d00003f80,0x3f6dbec4bf353f35,0xbf6dbec43f800000,0xbec4bf6d3f353f35
.quad 0x3f35bf3500003f80,0x3f353f35bf800000,0xbf35bf353f800000,0x3f35bf3500003f80,0x3f6dbec400003f80,0xbec43f6dbf35bf35,0xbec4bf6d3f800000,0x3f6d3ec4bf353f35
.quad 0x3f80000000003f80,0xbf8000000000bf80,0xbf803f800000,0x3f80bf800000,0x3f6d3ec400003f80,0xbec4bf6d3f35bf35,0x3ec4bf6d3f800000,0xbf6d3ec4bf35bf35
.quad 0x3f353f3500003f80,0x3f35bf353f800000,0x3f35bf353f800000,0xbf35bf350000bf80,0x3ec43f6d00003f80,0x3f6d3ec43f353f35,0x3f6dbec43f800000,0x3ec4bf6d3f35bf35
.quad 0xbf8000003f80,0xbf8000003f80,0xbf8000003f800000,0xbf8000003f800000,0x3f6d3ec4bf800000,0x3ec43f6dbf35bf35,0x3ec4bf6d00003f80,0x3f6dbec4bf353f35
.quad 0xbf353f350000bf80,0xbf35bf353f800000,0x3f353f35bf800000,0xbf353f350000bf80,0xbec4bf6d3f800000,0x3f6d3ec4bf353f35,0xbf6d3ec40000bf80,0x3ec4bf6d3f353f35
.quad 0x3f80000000003f80,0xbf8000000000bf80,0xbf803f800000,0x3f80bf800000,0xbec43f6dbf800000,0x3f6dbec43f353f35,0x3f6d3ec400003f80,0xbec4bf6d3f35bf35
.quad 0xbf35bf350000bf80,0xbf353f35bf800000,0xbf353f35bf800000,0x3f353f3500003f80,0x3f6dbec43f800000,0x3ec4bf6d3f35bf35,0xbec4bf6d0000bf80,0xbf6dbec4bf35bf35
.quad 0xbf8000003f80,0xbf8000003f80,0xbf8000003f800000,0xbf8000003f800000,0xbec43f6d0000bf80,0xbf6d3ec43f35bf35,0x3f6d3ec4bf800000,0x3ec43f6dbf35bf35
.quad 0x3f35bf3500003f80,0x3f353f35bf800000,0xbf35bf353f800000,0x3f35bf3500003f80,0xbf6d3ec40000bf80,0x3ec4bf6d3f353f35,0x3ec43f6dbf800000,0xbf6dbec43f35bf35
.quad 0x3f80000000003f80,0xbf8000000000bf80,0xbf803f800000,0x3f80bf800000,0xbf6dbec40000bf80,0x3ec43f6dbf353f35,0xbec43f6dbf800000,0x3f6dbec43f353f35
.quad 0x3f353f3500003f80,0x3f35bf353f800000,0x3f35bf353f800000,0xbf35bf350000bf80,0xbec4bf6d0000bf80,0xbf6dbec4bf35bf35,0xbf6d3ec4bf800000,0xbec43f6dbf353f35
.quad 0xbf8000003f80,0xbf8000003f80,0xbf8000003f800000,0xbf8000003f800000,0xbf6dbec43f800000,0xbec4bf6d3f353f35,0xbec43f6d0000bf80,0xbf6d3ec43f35bf35
.quad 0xbf353f350000bf80,0xbf35bf353f800000,0x3f353f35bf800000,0xbf353f350000bf80,0x3ec43f6dbf800000,0xbf6dbec43f35bf35,0x3f6dbec400003f80,0xbec43f6dbf35bf35
.quad 0x3f80000000003f80,0xbf8000000000bf80,0xbf803f800000,0x3f80bf800000,0x3ec4bf6d3f800000,0xbf6d3ec4bf35bf35,0xbf6dbec40000bf80,0x3ec43f6dbf353f35
.quad 0xbf35bf350000bf80,0xbf353f35bf800000,0xbf353f35bf800000,0x3f353f3500003f80,0xbf6d3ec4bf800000,0xbec43f6dbf353f35,0x3ec43f6d00003f80,0x3f6d3ec43f353f35
.quad 0x3f8000003f80,0x3f8000003f80,0xbec43f6d00003f80,0xbf6d3ec4bf353f35,0xbf353f3500003f80,0xbf35bf35bf800000,0xbf6d3ec400003f80,0x3ec4bf6dbf35bf35
.quad 0xbf80000000003f80,0x3f8000000000bf80,0xbf6dbec400003f80,0x3ec43f6d3f35bf35,0xbf35bf3500003f80,0xbf353f353f800000,0xbec4bf6d00003f80,0xbf6dbec43f353f35
.quad 0xbf8000003f80,0xbf8000003f80,0x3ec4bf6d00003f80,0x3f6dbec4bf353f35,0x3f35bf3500003f80,0x3f353f35bf800000,0x3f6dbec400003f80,0xbec43f6dbf35bf35
.quad 0x3f80000000003f80,0xbf8000000000bf80,0x3f6d3ec400003f80,0xbec4bf6d3f35bf35,0x3f353f3500003f80,0x3f35bf353f800000,0x3ec43f6d00003f80,0x3f6d3ec43f353f35
.quad 0x3f8000003f80,0x3f8000003f80,0xbf6dbec4bf800000,0xbec4bf6dbf35bf35,0x3f35bf350000bf80,0x3f353f353f800000,0x3ec43f6d3f800000,0xbf6dbec4bf353f35
.quad 0xbf80000000003f80,0x3f8000000000bf80,0x3ec4bf6dbf800000,0xbf6d3ec43f353f35,0x3f353f350000bf80,0x3f35bf35bf800000,0xbf6d3ec43f800000,0xbec43f6d3f35bf35
.quad 0xbf8000003f80,0xbf8000003f80,0x3f6d3ec4bf800000,0x3ec43f6dbf35bf35,0xbf353f350000bf80,0xbf35bf353f800000,0xbec4bf6d3f800000,0x3f6d3ec4bf353f35
.quad 0x3f80000000003f80,0xbf8000000000bf80,0xbec43f6dbf800000,0x3f6dbec43f353f35,0xbf35bf350000bf80,0xbf353f35bf800000,0x3f6dbec43f800000,0x3ec4bf6d3f35bf35
.quad 0x3f8000003f80,0x3f8000003f80,0x3ec4bf6d0000bf80,0x3f6dbec43f35bf35,0xbf353f3500003f80,0xbf35bf35bf800000,0x3f6dbec40000bf80,0xbec43f6d3f353f35
.quad 0xbf80000000003f80,0x3f8000000000bf80,0x3f6d3ec40000bf80,0xbec4bf6dbf353f35,0xbf35bf3500003f80,0xbf353f353f800000,0x3ec43f6d0000bf80,0x3f6d3ec4bf35bf35
.quad 0xbf8000003f80,0xbf8000003f80,0xbec43f6d0000bf80,0xbf6d3ec43f35bf35,0x3f35bf3500003f80,0x3f353f35bf800000,0xbf6d3ec40000bf80,0x3ec4bf6d3f353f35
.quad 0x3f80000000003f80,0xbf8000000000bf80,0xbf6dbec40000bf80,0x3ec43f6dbf353f35,0x3f353f3500003f80,0x3f35bf353f800000,0xbec4bf6d0000bf80,0xbf6dbec4bf35bf35
.quad 0x3f8000003f80,0x3f8000003f80,0x3f6d3ec43f800000,0x3ec43f6d3f353f35,0x3f35bf350000bf80,0x3f353f353f800000,0xbec4bf6dbf800000,0x3f6d3ec43f35bf35
.quad 0xbf80000000003f80,0x3f8000000000bf80,0xbec43f6d3f800000,0x3f6dbec4bf35bf35,0x3f353f350000bf80,0x3f35bf35bf800000,0x3f6dbec4bf800000,0x3ec4bf6dbf353f35
.quad 0xbf8000003f80,0xbf8000003f80,0xbf6dbec43f800000,0xbec4bf6d3f353f35,0xbf353f350000bf80,0xbf35bf353f800000,0x3ec43f6dbf800000,0xbf6dbec43f35bf35
.quad 0x3f80000000003f80,0xbf8000000000bf80,0x3ec4bf6d3f800000,0xbf6d3ec4bf35bf35,0xbf35bf350000bf80,0xbf353f35bf800000,0xbf6d3ec4bf800000,0xbec43f6dbf353f35
.quad 0x3f8000003f800000,0x3f8000003f800000,0x3f6d3ec43f800000,0x3ec43f6d3f353f35,0x3f353f353f800000,0xbf353f3500003f80,0x3ec43f6d3f800000,0xbf6dbec4bf353f35
.quad 0x3f803f800000,0xbf80bf800000,0xbec43f6d3f800000,0x3f6dbec4bf35bf35,0xbf353f353f800000,0x3f353f350000bf80,0xbf6d3ec43f800000,0xbec43f6d3f35bf35
.quad 0xbf8000003f800000,0xbf8000003f800000,0xbf6dbec43f800000,0xbec4bf6d3f353f35,0xbf35bf353f800000,0x3f35bf3500003f80,0xbec4bf6d3f800000,0x3f6d3ec4bf353f35
.quad 0xbf803f800000,0x3f80bf800000,0x3ec4bf6d3f800000,0xbf6d3ec4bf35bf35,0x3f35bf353f800000,0xbf35bf350000bf80,0x3f6dbec43f800000,0x3ec4bf6d3f35bf35
.quad 0x3f8000003f800000,0x3f8000003f800000,0xbec43f6d00003f80,0xbf6d3ec4bf353f35,0xbf35bf35bf800000,0x3f35bf350000bf80,0x3f6dbec40000bf80,0xbec43f6d3f353f35
.quad 0x3f803f800000,0xbf80bf800000,0xbf6dbec400003f80,0x3ec43f6d3f35bf35,0x3f35bf35bf800000,0xbf35bf3500003f80,0x3ec43f6d0000bf80,0x3f6d3ec4bf35bf35
.quad 0xbf8000003f800000,0xbf8000003f800000,0x3ec4bf6d00003f80,0x3f6dbec4bf353f35,0x3f353f35bf800000,0xbf353f350000bf80,0xbf6d3ec40000bf80,0x3ec4bf6d3f353f35
.quad 0xbf803f800000,0x3f80bf800000,0x3f6d3ec400003f80,0xbec4bf6d3f35bf35,0xbf353f35bf800000,0x3f353f3500003f80,0xbec4bf6d0000bf80,0xbf6dbec4bf35bf35
.quad 0x3f8000003f800000,0x3f8000003f800000,0xbf6dbec4bf800000,0xbec4bf6dbf35bf35,0x3f353f353f800000,0xbf353f3500003f80,0xbec4bf6dbf800000,0x3f6d3ec43f35bf35
.quad 0x3f803f800000,0xbf80bf800000,0x3ec4bf6dbf800000,0xbf6d3ec43f353f35,0xbf353f353f800000,0x3f353f350000bf80,0x3f6dbec4bf800000,0x3ec4bf6dbf353f35
.quad 0xbf8000003f800000,0xbf8000003f800000,0x3f6d3ec4bf800000,0x3ec43f6dbf35bf35,0xbf35bf353f800000,0x3f35bf3500003f80,0x3ec43f6dbf800000,0xbf6dbec43f35bf35
.quad 0xbf803f800000,0x3f80bf800000,0xbec43f6dbf800000,0x3f6dbec43f353f35,0x3f35bf353f800000,0xbf35bf350000bf80,0xbf6d3ec4bf800000,0xbec43f6dbf353f35
.quad 0x3f8000003f800000,0x3f8000003f800000,0x3ec4bf6d0000bf80,0x3f6dbec43f35bf35,0xbf35bf35bf800000,0x3f35bf350000bf80,0xbf6d3ec400003f80,0x3ec4bf6dbf35bf35
.quad 0x3f803f800000,0xbf80bf800000,0x3f6d3ec40000bf80,0xbec4bf6dbf353f35,0x3f35bf35bf800000,0xbf35bf3500003f80,0xbec4bf6d00003f80,0xbf6dbec43f353f35
.quad 0xbf8000003f800000,0xbf8000003f800000,0xbec43f6d0000bf80,0xbf6d3ec43f35bf35,0x3f353f35bf800000,0xbf353f350000bf80,0x3f6dbec400003f80,0xbec43f6dbf35bf35
.quad 0xbf803f800000,0x3f80bf800000,0xbf6dbec40000bf80,0x3ec43f6dbf353f35,0xbf353f35bf800000,0x3f353f3500003f80,0x3ec43f6d00003f80,0x3f6d3ec43f353f35
.quad 0xbe483f7b00003f80,0xbf0e3f55bec43f6d,0xbf0e3f5500003f80,0xbf7bbe48bf6d3ec4,0xbf553f0e00003f80,0xbe48bf7bbf6dbec4,0xbf7b3e4800003f80,0x3f55bf0ebec4bf6d
.quad 0xbf7bbe4800003f80,0x3f553f0e3ec4bf6d,0xbf55bf0e00003f80,0xbe483f7b3f6dbec4,0xbf0ebf5500003f80,0xbf7b3e483f6d3ec4,0xbe48bf7b00003f80,0xbf0ebf553ec43f6d
.quad 0x3e48bf7b00003f80,0x3f0ebf55bec43f6d,0x3f0ebf5500003f80,0x3f7b3e48bf6d3ec4,0x3f55bf0e00003f80,0x3e483f7bbf6dbec4,0x3f7bbe4800003f80,0xbf553f0ebec4bf6d
.quad 0x3f7b3e4800003f80,0xbf55bf0e3ec4bf6d,0x3f553f0e00003f80,0x3e48bf7b3f6dbec4,0x3f0e3f5500003f80,0x3f7bbe483f6d3ec4,0x3e483f7b00003f80,0x3f0e3f553ec43f6d
.quad 0xbf553f0ebf353f35,0xbf7b3e48bf6d3ec4,0xbe48bf7bbf35bf35,0x3f55bf0e3ec4bf6d,0x3f7b3e483f35bf35,0xbf0e3f553ec43f6d,0xbf0e3f553f353f35,0x3e48bf7bbf6dbec4
.quad 0xbf0ebf55bf353f35,0x3e483f7b3f6dbec4,0x3f7bbe48bf35bf35,0xbf0ebf55bec43f6d,0xbe483f7b3f35bf35,0x3f553f0ebec4bf6d,0xbf55bf0e3f353f35,0xbf7bbe483f6d3ec4
.quad 0x3f55bf0ebf353f35,0x3f7bbe48bf6d3ec4,0x3e483f7bbf35bf35,0xbf553f0e3ec4bf6d,0xbf7bbe483f35bf35,0x3f0ebf553ec43f6d,0x3f0ebf553f353f35,0xbe483f7bbf6dbec4
.quad 0x3f0e3f55bf353f35,0xbe48bf7b3f6dbec4,0xbf7b3e48bf35bf35,0x3f0e3f55bec43f6d,0x3e48bf7b3f35bf35,0xbf55bf0ebec4bf6d,0x3f553f0e3f353f35,0x3f7b3e483f6d3ec4
.quad 0xbf7bbe48bf800000,0xbf55bf0ebf6dbec4,0x3f553f0e3f800000,0xbe483f7b3ec43f6d,0xbf0ebf55bf800000,0x3f7bbe483ec4bf6d,0x3e483f7b3f800000,0xbf0ebf55bf6d3ec4
.quad 0x3e48bf7bbf800000,0xbf0e3f553f6d3ec4,0xbf0e3f553f800000,0x3f7b3e48bec4bf6d,0x3f55bf0ebf800000,0xbe48bf7bbec43f6d,0xbf7b3e483f800000,0xbf553f0e3f6dbec4
.quad 0x3f7b3e48bf800000,0x3f553f0ebf6dbec4,0xbf55bf0e3f800000,0x3e48bf7b3ec43f6d,0x3f0e3f55bf800000,0xbf7b3e483ec4bf6d,0xbe48bf7b3f800000,0x3f0e3f55bf6d3ec4
.quad 0xbe483f7bbf800000,0x3f0ebf553f6d3ec4,0x3f0ebf553f800000,0xbf7bbe48bec4bf6d,0xbf553f0ebf800000,0x3e483f7bbec43f6d,0x3f7bbe483f800000,0x3f55bf0e3f6dbec4
.quad 0xbf0ebf55bf35bf35,0xbe48bf7bbec4bf6d,0xbf7b3e48bf353f35,0xbf0ebf55bf6dbec4,0xbe483f7b3f353f35,0xbf55bf0ebf6d3ec4,0x3f553f0e3f35bf35,0xbf7bbe48bec43f6d
.quad 0x3f55bf0ebf35bf35,0xbf7b3e483ec43f6d,0xbe48bf7bbf353f35,0xbf553f0e3f6d3ec4,0xbf7bbe483f353f35,0xbf0e3f553f6dbec4,0xbf0e3f553f35bf35,0xbe483f7b3ec4bf6d
.quad 0x3f0e3f55bf35bf35,0x3e483f7bbec4bf6d,0x3f7bbe48bf353f35,0x3f0e3f55bf6dbec4,0x3e48bf7b3f353f35,0x3f553f0ebf6d3ec4,0xbf55bf0e3f35bf35,0x3f7b3e48bec43f6d
.quad 0xbf553f0ebf35bf35,0x3f7bbe483ec43f6d,0x3e483f7bbf353f35,0x3f55bf0e3f6d3ec4,0x3f7b3e483f353f35,0x3f0ebf553f6dbec4,0x3f0ebf553f35bf35,0x3e48bf7b3ec4bf6d
.quad 0x3f7b3e483f800000,0x3f553f0e3f6d3ec4,0x3f553f0e3f800000,0xbe483f7b3ec43f6d,0x3f0e3f553f800000,0xbf7b3e48bec43f6d,0x3e483f7b3f800000,0xbf0ebf55bf6d3ec4
.quad 0xbe483f7b3f800000,0x3f0ebf55bf6dbec4,0xbf0e3f553f800000,0x3f7b3e48bec4bf6d,0xbf553f0e3f800000,0x3e483f7b3ec4bf6d,0xbf7b3e483f800000,0xbf553f0e3f6dbec4
.quad 0xbf7bbe483f800000,0xbf55bf0e3f6d3ec4,0xbf55bf0e3f800000,0x3e48bf7b3ec43f6d,0xbf0ebf553f800000,0x3f7bbe48bec43f6d,0xbe48bf7b3f800000,0x3f0e3f55bf6d3ec4
.quad 0x3e48bf7b3f800000,0xbf0e3f55bf6dbec4,0x3f0ebf553f800000,0xbf7bbe48bec4bf6d,0x3f55bf0e3f800000,0xbe48bf7b3ec4bf6d,0x3f7bbe483f800000,0x3f55bf0e3f6dbec4
.quad 0x3f0e3f553f353f35,0x3e483f7b3ec43f6d,0xbf7b3e48bf353f35,0xbf0ebf55bf6dbec4,0x3e48bf7bbf35bf35,0x3f553f0e3f6dbec4,0x3f553f0e3f35bf35,0xbf7bbe48bec43f6d
.quad 0xbf553f0e3f353f35,0x3f7bbe48bec4bf6d,0xbe48bf7bbf353f35,0xbf553f0e3f6d3ec4,0x3f7b3e48bf35bf35,0x3f0ebf55bf6d3ec4,0xbf0e3f553f35bf35,0xbe483f7b3ec4bf6d
.quad 0xbf0ebf553f353f35,0xbe48bf7b3ec43f6d,0x3f7bbe48bf353f35,0x3f0e3f55bf6dbec4,0xbe483f7bbf35bf35,0xbf55bf0e3f6dbec4,0xbf55bf0e3f35bf35,0x3f7b3e48bec43f6d
.quad 0x3f55bf0e3f353f35,0xbf7b3e48bec4bf6d,0x3e483f7bbf353f35,0x3f55bf0e3f6d3ec4,0xbf7bbe48bf35bf35,0xbf0e3f55bf6d3ec4,0x3f0ebf553f35bf35,0x3e48bf7b3ec4bf6d
.quad 0xbe483f7b00003f80,0xbf0e3f55bec43f6d,0x3f0ebf550000bf80,0x3f7b3e483f6dbec4,0xbf553f0e00003f80,0xbe48bf7bbf6dbec4,0x3f7bbe480000bf80,0xbf553f0e3ec43f6d
.quad 0xbf7bbe4800003f80,0x3f553f0e3ec4bf6d,0x3f553f0e0000bf80,0x3e48bf7bbf6d3ec4,0xbf0ebf5500003f80,0xbf7b3e483f6d3ec4,0x3e483f7b0000bf80,0x3f0e3f55bec4bf6d
.quad 0x3e48bf7b00003f80,0x3f0ebf55bec43f6d,0xbf0e3f550000bf80,0xbf7bbe483f6dbec4,0x3f55bf0e00003f80,0x3e483f7bbf6dbec4,0xbf7b3e480000bf80,0x3f55bf0e3ec43f6d
.quad 0x3f7b3e4800003f80,0xbf55bf0e3ec4bf6d,0xbf55bf0e0000bf80,0xbe483f7bbf6d3ec4,0x3f0e3f5500003f80,0x3f7bbe483f6d3ec4,0xbe48bf7b0000bf80,0xbf0ebf55bec4bf6d
.quad 0xbf553f0ebf353f35,0xbf7b3e48bf6d3ec4,0x3e483f7b3f353f35,0xbf553f0ebec43f6d,0x3f7b3e483f35bf35,0xbf0e3f553ec43f6d,0x3f0ebf55bf35bf35,0xbe483f7b3f6d3ec4
.quad 0xbf0ebf55bf353f35,0x3e483f7b3f6dbec4,0xbf7b3e483f353f35,0x3f0e3f553ec4bf6d,0xbe483f7b3f35bf35,0x3f553f0ebec4bf6d,0x3f553f0ebf35bf35,0x3f7b3e48bf6dbec4
.quad 0x3f55bf0ebf353f35,0x3f7bbe48bf6d3ec4,0xbe48bf7b3f353f35,0x3f55bf0ebec43f6d,0xbf7bbe483f35bf35,0x3f0ebf553ec43f6d,0xbf0e3f55bf35bf35,0x3e48bf7b3f6d3ec4
.quad 0x3f0e3f55bf353f35,0xbe48bf7b3f6dbec4,0x3f7bbe483f353f35,0xbf0ebf553ec4bf6d,0x3e48bf7b3f35bf35,0xbf55bf0ebec4bf6d,0xbf55bf0ebf35bf35,0xbf7bbe48bf6dbec4
.quad 0x3f8000003f80,0x3f8000003f80,0x3ec43f6d00003f80,0x3f6d3ec43f353f35,0x3f353f3500003f80,0x3f35bf353f800000,0x3f6d3ec400003f80,0xbec4bf6d3f35bf35
.quad 0x3f80000000003f80,0xbf8000000000bf80,0x3f6dbec400003f80,0xbec43f6dbf35bf35,0x3f35bf3500003f80,0x3f353f35bf800000,0x3ec4bf6d00003f80,0x3f6dbec4bf353f35
.quad 0xbf8000003f80,0xbf8000003f80,0xbec4bf6d00003f80,0xbf6dbec43f353f35,0xbf35bf3500003f80,0xbf353f353f800000,0xbf6dbec400003f80,0x3ec43f6d3f35bf35
.quad 0xbf80000000003f80,0x3f8000000000bf80,0xbf6d3ec400003f80,0x3ec4bf6dbf35bf35,0xbf353f3500003f80,0xbf35bf35bf800000,0xbec43f6d00003f80,0xbf6d3ec4bf353f35
.quad 0x3f8000003f80,0x3f8000003f80,0x3f6dbec43f800000,0x3ec4bf6d3f35bf35,0xbf35bf350000bf80,0xbf353f35bf800000,0xbec43f6dbf800000,0x3f6dbec43f353f35
.quad 0x3f80000000003f80,0xbf8000000000bf80,0xbec4bf6d3f800000,0x3f6d3ec4bf353f35,0xbf353f350000bf80,0xbf35bf353f800000,0x3f6d3ec4bf800000,0x3ec43f6dbf35bf35
.quad 0xbf8000003f80,0xbf8000003f80,0xbf6d3ec43f800000,0xbec43f6d3f35bf35,0x3f353f350000bf80,0x3f35bf35bf800000,0x3ec4bf6dbf800000,0xbf6d3ec43f353f35
.quad 0xbf80000000003f80,0x3f8000000000bf80,0x3ec43f6d3f800000,0xbf6dbec4bf353f35,0x3f35bf350000bf80,0x3f353f353f800000,0xbf6dbec4bf800000,0xbec4bf6dbf35bf35
.quad 0x3f8000003f80,0x3f8000003f80,0xbec4bf6d0000bf80,0xbf6dbec4bf35bf35,0x3f353f3500003f80,0x3f35bf353f800000,0xbf6dbec40000bf80,0x3ec43f6dbf353f35
.quad 0x3f80000000003f80,0xbf8000000000bf80,0xbf6d3ec40000bf80,0x3ec4bf6d3f353f35,0x3f35bf3500003f80,0x3f353f35bf800000,0xbec43f6d0000bf80,0xbf6d3ec43f35bf35
.quad 0xbf8000003f80,0xbf8000003f80,0x3ec43f6d0000bf80,0x3f6d3ec4bf35bf35,0xbf35bf3500003f80,0xbf353f353f800000,0x3f6d3ec40000bf80,0xbec4bf6dbf353f35
.quad 0xbf80000000003f80,0x3f8000000000bf80,0x3f6dbec40000bf80,0xbec43f6d3f353f35,0xbf353f3500003f80,0xbf35bf35bf800000,0x3ec4bf6d0000bf80,0x3f6dbec43f35bf35
.quad 0x3f8000003f80,0x3f8000003f80,0xbf6d3ec4bf800000,0xbec43f6dbf353f35,0xbf35bf350000bf80,0xbf353f35bf800000,0x3ec4bf6d3f800000,0xbf6d3ec4bf35bf35
.quad 0x3f80000000003f80,0xbf8000000000bf80,0x3ec43f6dbf800000,0xbf6dbec43f35bf35,0xbf353f350000bf80,0xbf35bf353f800000,0xbf6dbec43f800000,0xbec4bf6d3f353f35
.quad 0xbf8000003f80,0xbf8000003f80,0x3f6dbec4bf800000,0x3ec4bf6dbf353f35,0x3f353f350000bf80,0x3f35bf35bf800000,0xbec43f6d3f800000,0x3f6dbec4bf35bf35
.quad 0xbf80000000003f80,0x3f8000000000bf80,0xbec4bf6dbf800000,0x3f6d3ec43f35bf35,0x3f35bf350000bf80,0x3f353f353f800000,0x3f6d3ec43f800000,0x3ec43f6d3f353f35
.quad 0xbf800000bf800000,0xbf800000bf800000,0xbf6d3ec4bf800000,0xbec43f6dbf353f35,0xbf353f35bf800000,0x3f353f3500003f80,0xbec43f6dbf800000,0x3f6dbec43f353f35
.quad 0x3f80bf800000,0xbf803f800000,0x3ec43f6dbf800000,0xbf6dbec43f35bf35,0x3f353f35bf800000,0xbf353f350000bf80,0x3f6d3ec4bf800000,0x3ec43f6dbf35bf35
.quad 0x3f800000bf800000,0x3f800000bf800000,0x3f6dbec4bf800000,0x3ec4bf6dbf353f35,0x3f35bf35bf800000,0xbf35bf3500003f80,0x3ec4bf6dbf800000,0xbf6d3ec43f353f35
.quad 0xbf80bf800000,0x3f803f800000,0xbec4bf6dbf800000,0x3f6d3ec43f35bf35,0xbf35bf35bf800000,0x3f35bf350000bf80,0xbf6dbec4bf800000,0xbec4bf6dbf35bf35
.quad 0xbf800000bf800000,0xbf800000bf800000,0x3ec43f6d00003f80,0x3f6d3ec43f353f35,0x3f35bf353f800000,0xbf35bf350000bf80,0xbf6dbec40000bf80,0x3ec43f6dbf353f35
.quad 0x3f80bf800000,0xbf803f800000,0x3f6dbec400003f80,0xbec43f6dbf35bf35,0xbf35bf353f800000,0x3f35bf3500003f80,0xbec43f6d0000bf80,0xbf6d3ec43f35bf35
.quad 0x3f800000bf800000,0x3f800000bf800000,0xbec4bf6d00003f80,0xbf6dbec43f353f35,0xbf353f353f800000,0x3f353f350000bf80,0x3f6d3ec40000bf80,0xbec4bf6dbf353f35
.quad 0xbf80bf800000,0x3f803f800000,0xbf6d3ec400003f80,0x3ec4bf6dbf35bf35,0x3f353f353f800000,0xbf353f3500003f80,0x3ec4bf6d0000bf80,0x3f6dbec43f35bf35
.quad 0xbf800000bf800000,0xbf800000bf800000,0x3f6dbec43f800000,0x3ec4bf6d3f35bf35,0xbf353f35bf800000,0x3f353f3500003f80,0x3ec4bf6d3f800000,0xbf6d3ec4bf35bf35
.quad 0x3f80bf800000,0xbf803f800000,0xbec4bf6d3f800000,0x3f6d3ec4bf353f35,0x3f353f35bf800000,0xbf353f350000bf80,0xbf6dbec43f800000,0xbec4bf6d3f353f35
.quad 0x3f800000bf800000,0x3f800000bf800000,0xbf6d3ec43f800000,0xbec43f6d3f35bf35,0x3f35bf35bf800000,0xbf35bf3500003f80,0xbec43f6d3f800000,0x3f6dbec4bf35bf35
.quad 0xbf80bf800000,0x3f803f800000,0x3ec43f6d3f800000,0xbf6dbec4bf353f35,0xbf35bf35bf800000,0x3f35bf350000bf80,0x3f6d3ec43f800000,0x3ec43f6d3f353f35
.quad 0xbf800000bf800000,0xbf800000bf800000,0xbec4bf6d0000bf80,0xbf6dbec4bf35bf35,0x3f35bf353f800000,0xbf35bf350000bf80,0x3f6d3ec400003f80,0xbec4bf6d3f35bf35
.quad 0x3f80bf800000,0xbf803f800000,0xbf6d3ec40000bf80,0x3ec4bf6d3f353f35,0xbf35bf353f800000,0x3f35bf3500003f80,0x3ec4bf6d00003f80,0x3f6dbec4bf353f35
.quad 0x3f800000bf800000,0x3f800000bf800000,0x3ec43f6d0000bf80,0x3f6d3ec4bf35bf35,0xbf353f353f800000,0x3f353f350000bf80,0xbf6dbec400003f80,0x3ec43f6d3f35bf35
.quad 0xbf80bf800000,0x3f803f800000,0x3f6dbec40000bf80,0xbec43f6d3f353f35,0x3f353f353f800000,0xbf353f3500003f80,0xbec43f6d00003f80,0xbf6d3ec4bf353f35
.quad 0xbe48bf7b0000bf80,0xbf0ebf55bec4bf6d,0xbf0ebf550000bf80,0xbf7b3e48bf6dbec4,0xbf55bf0e0000bf80,0xbe483f7bbf6d3ec4,0xbf7bbe480000bf80,0x3f553f0ebec43f6d
.quad 0xbf7b3e480000bf80,0x3f55bf0e3ec43f6d,0xbf553f0e0000bf80,0xbe48bf7b3f6d3ec4,0xbf0e3f550000bf80,0xbf7bbe483f6dbec4,0xbe483f7b0000bf80,0xbf0e3f553ec4bf6d
.quad 0x3e483f7b0000bf80,0x3f0e3f55bec4bf6d,0x3f0e3f550000bf80,0x3f7bbe48bf6dbec4,0x3f553f0e0000bf80,0x3e48bf7bbf6d3ec4,0x3f7b3e480000bf80,0xbf55bf0ebec43f6d
.quad 0x3f7bbe480000bf80,0xbf553f0e3ec43f6d,0x3f55bf0e0000bf80,0x3e483f7b3f6d3ec4,0x3f0ebf550000bf80,0x3f7b3e483f6dbec4,0x3e48bf7b0000bf80,0x3f0ebf553ec4bf6d
.quad 0xbf55bf0ebf35bf35,0xbf7bbe48bf6dbec4,0xbe483f7bbf353f35,0x3f553f0e3ec43f6d,0x3f7bbe483f353f35,0xbf0ebf553ec4bf6d,0xbf0ebf553f35bf35,0x3e483f7bbf6d3ec4
.quad 0xbf0e3f55bf35bf35,0x3e48bf7b3f6d3ec4,0x3f7b3e48bf353f35,0xbf0e3f55bec4bf6d,0xbe48bf7b3f353f35,0x3f55bf0ebec43f6d,0xbf553f0e3f35bf35,0xbf7b3e483f6dbec4
.quad 0x3f553f0ebf35bf35,0x3f7b3e48bf6dbec4,0x3e48bf7bbf353f35,0xbf55bf0e3ec43f6d,0xbf7b3e483f353f35,0x3f0e3f553ec4bf6d,0x3f0e3f553f35bf35,0xbe48bf7bbf6d3ec4
.quad 0x3f0ebf55bf35bf35,0xbe483f7b3f6d3ec4,0xbf7bbe48bf353f35,0x3f0ebf55bec4bf6d,0x3e483f7b3f353f35,0xbf553f0ebec43f6d,0x3f55bf0e3f35bf35,0x3f7bbe483f6dbec4
.quad 0xbf7b3e48bf800000,0xbf553f0ebf6d3ec4,0x3f55bf0e3f800000,0xbe48bf7b3ec4bf6d,0xbf0e3f55bf800000,0x3f7b3e483ec43f6d,0x3e48bf7b3f800000,0xbf0e3f55bf6dbec4
.quad 0x3e483f7bbf800000,0xbf0ebf553f6dbec4,0xbf0ebf553f800000,0x3f7bbe48bec43f6d,0x3f553f0ebf800000,0xbe483f7bbec4bf6d,0xbf7bbe483f800000,0xbf55bf0e3f6d3ec4
.quad 0x3f7bbe48bf800000,0x3f55bf0ebf6d3ec4,0xbf553f0e3f800000,0x3e483f7b3ec4bf6d,0x3f0ebf55bf800000,0xbf7bbe483ec43f6d,0xbe483f7b3f800000,0x3f0ebf55bf6dbec4
.quad 0xbe48bf7bbf800000,0x3f0e3f553f6dbec4,0x3f0e3f553f800000,0xbf7b3e48bec43f6d,0xbf55bf0ebf800000,0x3e48bf7bbec4bf6d,0x3f7b3e483f800000,0x3f553f0e3f6d3ec4
.quad 0xbf0e3f55bf353f35,0xbe483f7bbec43f6d,0xbf7bbe48bf35bf35,0xbf0e3f55bf6d3ec4,0xbe48bf7b3f35bf35,0xbf553f0ebf6dbec4,0x3f55bf0e3f353f35,0xbf7b3e48bec4bf6d
.quad 0x3f553f0ebf353f35,0xbf7bbe483ec4bf6d,0xbe483f7bbf35bf35,0xbf55bf0e3f6dbec4,0xbf7b3e483f35bf35,0xbf0ebf553f6d3ec4,0xbf0ebf553f353f35,0xbe48bf7b3ec43f6d
.quad 0x3f0ebf55bf353f35,0x3e48bf7bbec43f6d,0x3f7b3e48bf35bf35,0x3f0ebf55bf6d3ec4,0x3e483f7b3f35bf35,0x3f55bf0ebf6dbec4,0xbf553f0e3f353f35,0x3f7bbe48bec4bf6d
.quad 0xbf55bf0ebf353f35,0x3f7b3e483ec4bf6d,0x3e48bf7bbf35bf35,0x3f553f0e3f6dbec4,0x3f7bbe483f35bf35,0x3f0e3f553f6d3ec4,0x3f0e3f553f353f35,0x3e483f7b3ec43f6d
.quad 0x3f7bbe483f800000,0x3f55bf0e3f6dbec4,0x3f55bf0e3f800000,0xbe48bf7b3ec4bf6d,0x3f0ebf553f800000,0xbf7bbe48bec4bf6d,0x3e48bf7b3f800000,0xbf0e3f55bf6dbec4
.quad 0xbe48bf7b3f800000,0x3f0e3f55bf6d3ec4,0xbf0ebf553f800000,0x3f7bbe48bec43f6d,0xbf55bf0e3f800000,0x3e48bf7b3ec43f6d,0xbf7bbe483f800000,0xbf55bf0e3f6d3ec4
.quad 0xbf7b3e483f800000,0xbf553f0e3f6dbec4,0xbf553f0e3f800000,0x3e483f7b3ec4bf6d,0xbf0e3f553f800000,0x3f7b3e48bec4bf6d,0xbe483f7b3f800000,0x3f0ebf55bf6dbec4
.quad 0x3e483f7b3f800000,0xbf0ebf55bf6d3ec4,0x3f0e3f553f800000,0xbf7b3e48bec43f6d,0x3f553f0e3f800000,0xbe483f7b3ec43f6d,0x3f7b3e483f800000,0x3f553f0e3f6d3ec4
.quad 0x3f0ebf553f35bf35,0x3e48bf7b3ec4bf6d,0xbf7bbe48bf35bf35,0xbf0e3f55bf6d3ec4,0x3e483f7bbf353f35,0x3f55bf0e3f6d3ec4,0x3f55bf0e3f353f35,0xbf7b3e48bec4bf6d
.quad 0xbf55bf0e3f35bf35,0x3f7b3e48bec43f6d,0xbe483f7bbf35bf35,0xbf55bf0e3f6dbec4,0x3f7bbe48bf353f35,0x3f0e3f55bf6dbec4,0xbf0ebf553f353f35,0xbe48bf7b3ec43f6d
.quad 0xbf0e3f553f35bf35,0xbe483f7b3ec4bf6d,0x3f7b3e48bf35bf35,0x3f0ebf55bf6d3ec4,0xbe48bf7bbf353f35,0xbf553f0e3f6d3ec4,0xbf553f0e3f353f35,0x3f7bbe48bec4bf6d
.quad 0x3f553f0e3f35bf35,0xbf7bbe48bec43f6d,0x3e48bf7bbf35bf35,0x3f553f0e3f6dbec4,0xbf7b3e48bf353f35,0xbf0ebf55bf6dbec4,0x3f0e3f553f353f35,0x3e483f7b3ec43f6d
.quad 0xbe48bf7b0000bf80,0xbf0ebf55bec4bf6d,0x3f0e3f5500003f80,0x3f7bbe483f6d3ec4,0xbf55bf0e0000bf80,0xbe483f7bbf6d3ec4,0x3f7b3e4800003f80,0xbf55bf0e3ec4bf6d
.quad 0xbf7b3e480000bf80,0x3f55bf0e3ec43f6d,0x3f55bf0e00003f80,0x3e483f7bbf6dbec4,0xbf0e3f550000bf80,0xbf7bbe483f6dbec4,0x3e48bf7b00003f80,0x3f0ebf55bec43f6d
.quad 0x3e483f7b0000bf80,0x3f0e3f55bec4bf6d,0xbf0ebf5500003f80,0xbf7b3e483f6d3ec4,0x3f553f0e0000bf80,0x3e48bf7bbf6d3ec4,0xbf7bbe4800003f80,0x3f553f0e3ec4bf6d
.quad 0x3f7bbe480000bf80,0xbf553f0e3ec43f6d,0xbf553f0e00003f80,0xbe48bf7bbf6dbec4,0x3f0ebf550000bf80,0x3f7b3e483f6dbec4,0xbe483f7b00003f80,0xbf0e3f55bec43f6d
.quad 0xbf55bf0ebf35bf35,0xbf7bbe48bf6dbec4,0x3e48bf7b3f35bf35,0xbf55bf0ebec4bf6d,0x3f7bbe483f353f35,0xbf0ebf553ec4bf6d,0x3f0e3f55bf353f35,0xbe48bf7b3f6dbec4
.quad 0xbf0e3f55bf35bf35,0x3e48bf7b3f6d3ec4,0xbf7bbe483f35bf35,0x3f0ebf553ec43f6d,0xbe48bf7b3f353f35,0x3f55bf0ebec43f6d,0x3f55bf0ebf353f35,0x3f7bbe48bf6d3ec4
.quad 0x3f553f0ebf35bf35,0x3f7b3e48bf6dbec4,0xbe483f7b3f35bf35,0x3f553f0ebec4bf6d,0xbf7b3e483f353f35,0x3f0e3f553ec4bf6d,0xbf0ebf55bf353f35,0x3e483f7b3f6dbec4
.quad 0x3f0ebf55bf35bf35,0xbe483f7b3f6d3ec4,0x3f7b3e483f35bf35,0xbf0e3f553ec43f6d,0x3e483f7b3f353f35,0xbf553f0ebec43f6d,0xbf553f0ebf353f35,0xbf7b3e48bf6d3ec4
.quad 0x35cccccd354ccccd,0x35cccccd35cccccd,0x35ccc2b2354ccccd,0x35cc71de35cca461,0x35cca461354ccccd,0x35cb616335cc2b2e,0x35cc71de354ccccd,0x35c99c4e35cb6163
.quad 0x35cc2b2e354ccccd,0x35c7243035ca4751,0x35cbd057354ccccd,0x35c3fb3c35c8dd65,0x35cb6163354ccccd,0x35c0243f35c72430,0x35cade5d354ccccd,0x35bba2a335c51c60
.quad 0x35ca4751354ccccd,0x35b67a6735c2c6c0,0x35c99c4e354ccccd,0x35b0b02135c0243f,0x35c8dd65354ccccd,0x35aa48f435bd35e5,0x35c80aaa354ccccd,0x35a34a9135b9fcdb
.quad 0x35c72430354ccccd,0x359bbb2c35b67a67,0x35c62a0f354ccccd,0x3593a17d35b2afeb,0x35c51c60354ccccd,0x358b04b535ae9ee7,0x35c3fb3c354ccccd,0x3581ec7b35aa48f4
.quad 0x35cccccd35cccccd,0x35cccccd35cccccd,0x35cbd05735cc2b2e,0x35cade5d35cb6163,0x35c8dd6535ca4751,0x35c51c6035c72430,0x35c3fb3c35c72430,0x35bba2a335c0243f
.quad 0x35bd35e535c2c6c0,0x35ae9ee735b67a67,0x35b49e1335bd35e5,0x359e500335aa48f4,0x35aa48f435b67a67,0x358b04b5359bbb2c,0x359e500335ae9ee7,0x356a3450358b04b5
.quad 0x3590d0c335a5afca,0x3539f45b3570c1c0,0x3581ec7b359bbb2c,0x35063284354823a7,0x35638fc33590d0c3,0x349fd168351cbf44,0x35411588358501c8,0x33c0e86934de5d30
.quad 0x351cbf443570c1c0,0xb4008c21348026af,0x34edcd1c355603f2,0xb4af8fe33380a585,0x349fd1683539f45b,0xb50dc501b4008c21,0x3420975e351cbf44,0xb5411588b49fd168
.quad 0x35cccccd35cccccd,0x354ccccd,0x35c99c4e35ca4751,0x3548dd65,0x35c0243f35c2c6c0,0x353d35e5,0x35b0b02135b67a67,0x352a48f4
.quad 0x359bbb2c35a5afca,0x3510d0c3,0x3581ec7b3590d0c3,0x34e38fc3,0x354823a73570c1c0,0x349cbf44,0x350632843539f45b,0x341fd168
.quad 0x348026af34fd2590,0x0,0xb300abdf348026af,0xb41fd168,0xb49fd16800000000,0xb49cbf44,0xb5154980b48026af,0xb4e38fc3
.quad 0xb55603f2b4fd2590,0xb510d0c3,0xb58809f5b539f45b,0xb52a48f4,0xb5a0d539b570c1c0,0xb53d35e5,0xb5b49e13b590d0c3,0xb548dd65
.quad 0x0,0x0,0x0,0x0,0x0,0x0,0x0,0x0
.quad 0x0,0x0,0x0,0x0,0x0,0x0,0x0,0x0
.quad 0x0,0x0,0x0,0x0,0x0,0x0,0x0,0x0
.quad 0x0,0x0,0x0,0x0,0x0,0x0,0x0,0x0
.quad 0x35ccca46354ccccd,0x35ccb61035ccc2b2,0x35ccb610354ccccd,0x35cc004735cc71de,0x35cc8da6354ccccd,0x35ca955635cbd057,0x35cc510b354ccccd,0x35c8768135cade5d
.quad 0x35cc0047354ccccd,0x35c5a5a835c99c4e,0x35cb9b60354ccccd,0x35c2254b35c80aaa,0x35cb2261354ccccd,0x35bdf88835c62a0f,0x35ca9556354ccccd,0x35b9231335c3fb3c
.quad 0x35c9f44d354ccccd,0x35b3a93635c17f0c,0x35c93f55354ccccd,0x35ad8fd035beb67b,0x35c87681354ccccd,0x35a6dc4935bba2a3,0x35c799e3354ccccd,0x359f949635b844b9
.quad 0x35c6a993354ccccd,0x3597bf2e35b49e13,0x35c5a5a8354ccccd,0x358f630535b0b021,0x35c48e3a354ccccd,0x3586878835ac7c70,0x35c36367354ccccd,0x357a692835a804aa
.quad 0x35cc8da635cca461,0x35cc510b35cc71de,0x35ca955635cb6163,0x35c8768135c99c4e,0x35c6a99335c8dd65,0x35c0d40735c3fb3c,0x35c0d40735c51c60,0x35b58e7a35bba2a3
.quad 0x35b9231335c0243f,0x35a6dc4935b0b021,0x35afa9af35b9fcdb,0x3595046835a34a91,0x35a47f3535b2afeb,0x35805d003593a17d,0x3597bf2e35aa48f4,0x355293943581ec7b
.quad 0x3589890835a0d539,0x35207465355cd4c0,0x3573ff99359663a6,0x34d69ce73532c0d3,0x35529394358b04b5,0x3450898635063284,0x352f2067357d94b5,0xb280ad7534af8fe3
.quad 0x3509fd7635638fc3,0xb47067393420975e,0x34c70ca3354823a7,0xb4e617fdb300abdf,0x34706739352b7ba8,0xb527d2aeb4607b24,0x33a0c8f3350dc501,0xb5596f08b4ced752
.quad 0x35cc004735cc2b2e,0x354bd057,0x35c5a5a835c72430,0x3543fb3c,0x35b9231335bd35e5,0x35349e13,0x35a6dc4935ae9ee7,0x351e5003
.quad 0x358f6305359bbb2c,0x3501ec7b,0x3566e4e3358501c8,0x34c11588,0x3527d2ae355603f2,0x346dcd1c,0x34c70ca3351cbf44,0x33a0975e
.quad 0x33e1031c34bf3d0b,0xb3a0975e,0xb430973e34008c21,0xb46dcd1c,0xb4e617fdb4008c21,0xb4c11588,0xb5365cd7b4bf3d0b,0xb501ec7b
.quad 0xb573ff99b51cbf44,0xb51e5003,0xb5950468b55603f2,0xb5349e13,0xb5ab64d0b58501c8,0xb543fb3c,0xb5bc6e97b59bbb2c,0xb54bd057
.quad 0x0,0x0,0x0,0x0,0x0,0x0,0x0,0x0
.quad 0x0,0x0,0x0,0x0,0x0,0x0,0x0,0x0
.quad 0x0,0x0,0x0,0x0,0x0,0x0,0x0,0x0
.quad 0x0,0x0,0x0,0x0,0x0,0x0,0x0,0x0
.quad 0x0,0x0,0x3300abdf00000000,0x33c0e8693380a585,0x3380a58500000000,0x344092c234008c21,0x33c0e86900000000,0x34900327344092c2
.quad 0x34008c2100000000,0x34bf3d0b348026af,0x3420975e00000000,0x34edcd1c349fd168,0x344092c200000000,0x350dc50134bf3d0b,0x34607b2400000000,0x3524259034de5d30
.quad 0x348026af00000000,0x3539f45b34fd2590,0x3490032700000000,0x354f1e05350dc501,0x349fd16800000000,0x35638fc3351cbf44,0x34af8fe300000000,0x3577376d352b7ba8
.quad 0x34bf3d0b00000000,0x358501c83539f45b,0x34ced75200000000,0x358df1bd354823a7,0x34de5d3000000000,0x359663a6355603f2,0x34edcd1c00000000,0x359e500335638fc3
.quad 0x0,0x0,0x3420975e34008c21,0x34607b24344092c2,0x349fd168348026af,0x34de5d3034bf3d0b,0x34edcd1c34bf3d0b,0x35242590350dc501
.quad 0x351cbf4434fd2590,0x355603f23539f45b,0x35411588351cbf44,0x3581ec7b35638fc3,0x35638fc33539f45b,0x359663a6358501c8,0x3581ec7b355603f2,0x35a804aa359663a6
.quad 0x3590d0c33570c1c0,0x35b67a6735a5afca,0x359e5003358501c8,0x35c17f0c35b2afeb,0x35aa48f43590d0c3,0x35c8dd6535bd35e5,0x35b49e13359bbb2c,0x35cc71de35c51c60
.quad 0x35bd35e535a5afca,0x35cc2b2e35ca4751,0x35c3fb3c35ae9ee7,0x35c80aaa35cca461,0x35c8dd6535b67a67,0x35c0243f35cc2b2e,0x35cbd05735bd35e5,0x35b49e1335c8dd65
.quad 0x0,0x0,0x34900327348026af,0x341fd168,0x350dc50134fd2590,0x349cbf44,0x354f1e053539f45b,0x34e38fc3
.quad 0x358501c83570c1c0,0x3510d0c3,0x359e50033590d0c3,0x352a48f4,0x35b2afeb35a5afca,0x353d35e5,0x35c17f0c35b67a67,0x3548dd65
.quad 0x35ca475135c2c6c0,0x354ccccd,0x35ccc2b235ca4751,0x3548dd65,0x35c8dd6535cccccd,0x353d35e5,0x35beb67b35ca4751,0x352a48f4
.quad 0x35ae9ee735c2c6c0,0x3510d0c3,0x359916f735b67a67,0x34e38fc3,0x357d94b535a5afca,0x349cbf44,0x354115883590d0c3,0x341fd168
.quad 0x0,0x0,0x0,0x0,0x0,0x0,0x0,0x0
.quad 0x0,0x0,0x0,0x0,0x0,0x0,0x0,0x0
.quad 0x0,0x0,0x0,0x0,0x0,0x0,0x0,0x0
.quad 0x0,0x0,0x0,0x0,0x0,0x0,0x0,0x0
.quad 0x3280ad7500000000,0x3340fdd63300abdf,0x3340fdd600000000,0x3410938833c0e869,0x33a0c8f300000000,0x347067393420975e,0x33e1031c00000000,0x34a7b2b734607b24
.quad 0x3410938800000000,0x34d69ce734900327,0x3430973e00000000,0x3502644234af8fe3,0x3450898600000000,0x3519064634ced752,0x3470673900000000,0x352f206734edcd1c
.quad 0x3488169900000000,0x35449f0435063284,0x3497ec2700000000,0x35596f0835154980,0x34a7b2b700000000,0x356d7df635242590,0x34b768ba00000000,0x35805d003532c0d3
.quad 0x34c70ca300000000,0x3589890835411588,0x34d69ce700000000,0x35923aee354f1e05,0x34e617fd00000000,0x359a6af9355cd4c0,0x34f57c5d00000000,0x35a211e5356a3450
.quad 0x33a0c8f33380a585,0x33e1031c33c0e869,0x34706739344092c2,0x34a7b2b734900327,0x34c70ca3349fd168,0x3509fd7634edcd1c,0x3509fd7634de5d30,0x353d874835242590
.quad 0x352f2067350dc501,0x356d7df6354f1e05,0x35529394352b7ba8,0x358c7cf53577376d,0x3573ff99354823a7,0x359f9496358df1bd,0x3589890835638fc3,0x35afa9af359e5003
.quad 0x3597bf2e357d94b5,0x35bc6e9735ac7c70,0x35a47f35358b04b5,0x35c5a5a835b844b9,0x35afa9af359663a6,0x35cb226135c17f0c,0x35b9231335a0d539,0x35ccca4635c80aaa
.quad 0x35c0d40735aa48f4,0x35ca955635cbd057,0x35c6a99335b2afeb,0x35c48e3a35ccc2b2,0x35ca955635b9fcdb,0x35bad20d35cade5d,0x35cc8da635c0243f,0x35ad8fd035c62a0f
.quad 0x3410938834008c21,0x33a0975e,0x34d69ce734bf3d0b,0x346dcd1c,0x352f2067351cbf44,0x34c11588,0x356d7df6355603f2,0x3501ec7b
.quad 0x35923aee358501c8,0x351e5003,0x35a928e5359bbb2c,0x35349e13,0x35bad20d35ae9ee7,0x3543fb3c,0x35c6a99335bd35e5,0x354bd057
.quad 0x35cc510b35c72430,0x354bd057,0x35cb9b6035cc2b2e,0x3543fb3c,0x35c48e3a35cc2b2e,0x35349e13,0x35b761d335c72430,0x351e5003
.quad 0x35a47f3535bd35e5,0x3501ec7b,0x358c7cf535ae9ee7,0x34c11588,0x35603506359bbb2c,0x346dcd1c,0x35207465358501c8,0x33a0975e
.quad 0x0,0x0,0x0,0x0,0x0,0x0,0x0,0x0
.quad 0x0,0x0,0x0,0x0,0x0,0x0,0x0,0x0
.quad 0x0,0x0,0x0,0x0,0x0,0x0,0x0,0x0
.quad 0x0,0x0,0x0,0x0,0x0,0x0,0x0,0x0
.quad 0x3f8000003f80,0x3f8000003f80,0xbe9e3f7300003f80,0xbf4f3f16bf163f4f,0xbf163f4f00003f80,0xbf73be9ebf733e9e,0xbf4f3f1600003f80,0xbe9ebf73bf73be9e
.quad 0xbf80000000003f80,0x3f8000000000bf80,0xbf73be9e00003f80,0x3f163f4f3f16bf4f,0xbf4fbf1600003f80,0xbe9e3f733f73be9e,0xbf16bf4f00003f80,0xbf733e9e3f733e9e
.quad 0xbf8000003f80,0xbf8000003f80,0x3e9ebf7300003f80,0x3f4fbf16bf163f4f,0x3f16bf4f00003f80,0x3f733e9ebf733e9e,0x3f4fbf1600003f80,0x3e9e3f73bf73be9e
.quad 0x3f80000000003f80,0xbf8000000000bf80,0x3f733e9e00003f80,0xbf16bf4f3f16bf4f,0x3f4f3f1600003f80,0x3e9ebf733f73be9e,0x3f163f4f00003f80,0x3f73be9e3f733e9e
.quad 0x3f8000003f80,0x3f8000003f80,0xbf800000bf733e9e,0xbf4fbf16bf73be9e,0xbf80bf16bf4f,0x3f73be9e3f16bf4f,0x3f8000003f16bf4f,0xbe9e3f733f163f4f
.quad 0xbf80000000003f80,0x3f8000000000bf80,0xbf80bf733e9e,0xbf163f4f3f733e9e,0x3f800000bf16bf4f,0xbe9ebf73bf163f4f,0x3f803f16bf4f,0x3f733e9ebf16bf4f
.quad 0xbf8000003f80,0xbf8000003f80,0x3f800000bf733e9e,0x3f4f3f16bf73be9e,0x3f80bf16bf4f,0xbf733e9e3f16bf4f,0xbf8000003f16bf4f,0x3e9ebf733f163f4f
.quad 0x3f80000000003f80,0xbf8000000000bf80,0x3f80bf733e9e,0x3f16bf4f3f733e9e,0xbf800000bf16bf4f,0x3e9e3f73bf163f4f,0xbf803f16bf4f,0xbf73be9ebf16bf4f
.quad 0x3f8000003f80,0x3f80,0xbe9ebf73bf16bf4f,0xbf80,0x3f163f4f3f733e9e,0x3f80,0xbf4fbf16bf733e9e,0xbf80
.quad 0xbf80000000003f80,0xbf80,0x3f73be9ebf16bf4f,0x3f80,0xbf4f3f163f733e9e,0xbf80,0x3f16bf4fbf733e9e,0x3f80
.quad 0xbf8000003f80,0x3f80,0x3e9e3f73bf16bf4f,0xbf80,0xbf16bf4f3f733e9e,0x3f80,0x3f4f3f16bf733e9e,0xbf80
.quad 0x3f80000000003f80,0xbf80,0xbf733e9ebf16bf4f,0x3f80,0x3f4fbf163f733e9e,0xbf80,0xbf163f4fbf733e9e,0x3f80
.quad 0x0,0x0,0x0,0x0,0x0,0x0,0x0,0x0
.quad 0x0,0x0,0x0,0x0,0x0,0x0,0x0,0x0
.quad 0x0,0x0,0x0,0x0,0x0,0x0,0x0,0x0
.quad 0x0,0x0,0x0,0x0,0x0,0x0,0x0,0x0
.quad 0xbf733e9e00003f80,0x3f16bf4fbf16bf4f,0x0,0x0,0x0,0x0,0x0,0x0
.quad 0xbe9ebf7300003f80,0xbf4fbf163f163f4f,0x0,0x0,0x0,0x0,0x0,0x0
.quad 0x3f73be9e00003f80,0xbf163f4fbf16bf4f,0x0,0x0,0x0,0x0,0x0,0x0
.quad 0x3e9e3f7300003f80,0x3f4f3f163f163f4f,0x0,0x0,0x0,0x0,0x0,0x0
.quad 0x3f803f733e9e,0xbf16bf4fbf733e9e,0x0,0x0,0x0,0x0,0x0,0x0
.quad 0xbf8000003f733e9e,0xbf4f3f163f73be9e,0x0,0x0,0x0,0x0,0x0,0x0
.quad 0xbf803f733e9e,0x3f163f4fbf733e9e,0x0,0x0,0x0,0x0,0x0,0x0
.quad 0x3f8000003f733e9e,0x3f4fbf163f73be9e,0x0,0x0,0x0,0x0,0x0,0x0
.quad 0x3f733e9e3f16bf4f,0x3f80,0x0,0x0,0x0,0x0,0x0,0x0
.quad 0xbe9e3f733f16bf4f,0xbf80,0x0,0x0,0x0,0x0,0x0,0x0
.quad 0xbf73be9e3f16bf4f,0x3f80,0x0,0x0,0x0,0x0,0x0,0x0
.quad 0x3e9ebf733f16bf4f,0xbf80,0x0,0x0,0x0,0x0,0x0,0x0
.quad 0x0,0x0,0x0,0x0,0x0,0x0,0x0,0x0
.quad 0x0,0x0,0x0,0x0,0x0,0x0,0x0,0x0
.quad 0x0,0x0,0x0,0x0,0x0,0x0,0x0,0x0
.quad 0x0,0x0,0x0,0x0,0x0,0x0,0x0,0x0
.size tab_data, 32768
.section .rodata,"a"
.p2align 6
.amdhsa_kernel adaLN_cond__spectral_gfnet__glu_gated_bilinear__prompt_kernel
  .amdhsa_next_free_vgpr 256
  .amdhsa_next_free_sgpr 102
  .amdhsa_accum_offset 256
  .amdhsa_group_segment_fixed_size 0
  .amdhsa_kernarg_size 96
  .amdhsa_user_sgpr_count 2
  .amdhsa_user_sgpr_kernarg_segment_ptr 1
  .amdhsa_system_sgpr_workgroup_id_x 1
.end_amdhsa_kernel
```
